```python
import torch

def _softmax(x, axis=-1):
    return torch.softmax(x, dim=axis)
def _gelu(x):
    return torch.nn.functional.gelu(x, approximate="tanh")
def _silu(x):
    return torch.nn.functional.silu(x)
def _sigmoid(x):
    return torch.sigmoid(x)
def _layernorm(x, axis=-1, eps=1e-5):
    m = x.mean(dim=axis, keepdim=True)
    v = x.var(dim=axis, keepdim=True, unbiased=False)
    return (x - m) / torch.sqrt(v + eps)
def _scatter_add(tgt, idx, src, axis=0):
    return tgt.clone().index_add_(axis, idx, src)
def _segment_sum(src, seg, n):
    out = torch.zeros((n,) + src.shape[1:], dtype=src.dtype)
    return out.index_add_(0, seg, src)
def _pad(x, pw):
    flat = tuple(v for pair in reversed(pw) for v in pair)
    return torch.nn.functional.pad(x, flat)

kernel_name = 'standalone__seq2seq_rnn_t_joint__speech'

def setup_inputs():

    _w = (lambda a: (lambda t: t.to(torch.bfloat16) if t.is_floating_point() else t)(torch.as_tensor(a)))
    B, T, D, K = 2, 4000, 144, 31
    U = 8
    sc = (1.0 / (K * D)) ** 0.5
    sd = (1.0 / D) ** 0.5
    return {
        "x": _w((lambda *s: torch.randn(*s, dtype=torch.bfloat16) * 0.2)(B, T, D) * 0.5),
        "w1": _w((lambda *s: torch.randn(*s, dtype=torch.bfloat16) * 3.2)(K, D, D) * sc),
        "w2": _w((lambda *s: torch.randn(*s, dtype=torch.bfloat16) * 3.2)(K, D, D) * sc),
        "g": _w((lambda *s: torch.randn(*s, dtype=torch.bfloat16) * 3.2)(B, U, D) * 0.5),
        "w_f": _w((lambda *s: torch.randn(*s, dtype=torch.bfloat16) * 3.2)(D, D) * sd),
        "w_g": _w((lambda *s: torch.randn(*s, dtype=torch.bfloat16) * 3.2)(D, D) * sd),
        "w_o": _w((lambda *s: torch.randn(*s, dtype=torch.bfloat16) * 3.2)(D, D) * sd),
    }

def reference(x, w1, w2, g, w_f, w_g, w_o):
    B, T, D = x.shape
    K = w1.shape[0]
    pad = K // 2
    xp = _pad(x, ((0,0),(pad,pad),(0,0)))
    h = torch.zeros_like(x)
    for i in range(K):
        h = h + torch.einsum("btc,cd->btd", xp[:, i:i+T, :], w1[i])
    h = _gelu(h)[:, ::2, :]
    T1 = h.shape[1]
    hp = _pad(h, ((0,0),(pad,pad),(0,0)))
    f = torch.zeros_like(h)
    for i in range(K):
        f = f + torch.einsum("btc,cd->btd", hp[:, i:i+T1, :], w2[i])
    f = _gelu(f)[:, ::2, :]
    fe = torch.einsum("btd,de->bte", f, w_f)
    ge = torch.einsum("bud,de->bue", g, w_g)
    j = torch.tanh(fe[:, :, None, :] + ge[:, None, :, :])
    return torch.einsum("btud,dv->btuv", j, w_o)
```

```asm
; @launch grid=(256,1,1) block=(256,1,1) lds=159744
.amdgcn_target "amdgcn-amd-amdhsa--gfx950"
.text
.globl standalone__seq2seq_rnn_t_joint__speech_kernel
.p2align 12
.type standalone__seq2seq_rnn_t_joint__speech_kernel,@function
standalone__seq2seq_rnn_t_joint__speech_kernel:
  s_mov_b32 s80, 0
  s_cmp_ge_u32 s2, 256
  s_cbranch_scc1 L_exit
  s_load_dwordx16 s[4:19], s[0:1], 0
  s_load_dwordx4 s[20:23], s[0:1], 64
  s_getpc_b64 s[52:53]
L_pc:
  s_bfe_u32 s61, s2, 327683
  v_lshl_add_u32 v1, v0, 5, s61
  v_lshlrev_b32 v1, 7, v1
  v_min_u32 v1, L_codeend-L_pc-4, v1
  global_load_dword v255, v1, s[52:53]
  v_lshrrev_b32 v2, 6, v0
  v_and_b32 v1, 63, v0
  v_readfirstlane_b32 s59, v2
  s_lshl_b32 s61, s2, 2
  s_lshr_b32 s61, 1412567143, s61
  s_bfe_u32 s54, s61, 0x20001
  s_and_b32 s61, s61, 1
  s_lshl_b32 s61, s61, 5
  s_lshr_b32 s62, s2, 3
  s_add_u32 s61, s61, s62
  s_mul_i32 s55, s61, 37
  s_lshr_b32 s55, s55, 8
  s_mul_i32 s62, s55, 7
  s_sub_u32 s63, s61, s62
  s_mul_i32 s56, s54, 7
  s_add_u32 s56, s56, s63
  s_lshr_b32 s57, s54, 1
  s_mul_i32 s62, s57, 14
  s_sub_u32 s58, s56, s62
  s_mul_i32 s68, s57, 1152000
  s_mul_i32 s62, s61, 57
  s_lshr_b32 s62, s62, 9
  s_mul_i32 s63, s62, 9
  s_sub_u32 s79, s61, s63
  s_mul_i32 s81, s54, 7
  s_add_u32 s81, s81, s62
  v_lshlrev_b32 v2, 4, v1
  v_lshrrev_b32 v46, 1, v1
  v_and_b32 v47, 1, v1
  v_lshlrev_b32 v47, 4, v47
  v_mul_u32_u24 v48, 288, v46
  v_add_u32 v48, v48, v47
  v_lshrrev_b32 v46, 2, v1
  v_mul_u32_u24 v46, 576, v46
  v_and_b32 v47, 3, v1
  v_lshl_add_u32 v227, v47, 4, v46
  s_mul_i32 s61, s59, 36864
  s_add_u32 s61, s61, 12288
  s_add_u32 s90, s61, 11264
  s_and_b32 s62, s55, 3
  s_mul_i32 s62, s62, 3072
  s_add_u32 s89, s61, s62
  s_mul_i32 s62, s62, 9
  s_mul_i32 s61, s58, 82944
  s_sub_u32 s61, s61, 12928
  v_add_u32 v227, s61, v227
  s_lshl_b32 s61, s59, 6
  s_add_u32 s61, s61, s62
  v_add_u32 v219, s61, v227
  s_movk_i32 s91, 1024
  s_and_b32 s66, s81, 3
  s_lshl_b32 s64, s66, 5
  s_add_u32 s65, s64, -4464
  s_add_u32 s64, s64, 16
  s_mul_i32 s66, s66, 1152
  s_add_u32 s66, s66, -8944
  s_lshr_b32 s63, s81, 2
  s_mul_i32 s63, s63, 5
  s_lshl_b32 s67, s79, 5
  s_mul_i32 s79, s79, 28
  s_add_u32 s79, s79, s81
  s_cmp_lt_u32 s63, 31
  s_cselect_b32 s61, s65, s66
  s_cmp_lt_u32 s63, 16
  s_cselect_b32 s61, s64, s61
  s_mul_i32 s62, s63, 288
  s_add_u32 s61, s61, s62
  s_mul_i32 s61, s61, 288
  s_add_u32 s61, s61, s67
  s_add_u32 s74, s61, 0
  s_cmp_lt_u32 s63, 30
  s_cselect_b32 s61, s65, s66
  s_cmp_lt_u32 s63, 15
  s_cselect_b32 s61, s64, s61
  s_add_u32 s61, s61, s62
  s_mul_i32 s61, s61, 288
  s_add_u32 s61, s61, s67
  s_add_u32 s75, s61, 82944
  s_cmp_lt_u32 s63, 29
  s_cselect_b32 s61, s65, s66
  s_cmp_lt_u32 s63, 14
  s_cselect_b32 s61, s64, s61
  s_add_u32 s61, s61, s62
  s_mul_i32 s61, s61, 288
  s_add_u32 s61, s61, s67
  s_add_u32 s76, s61, 163840
  s_cmp_lt_u32 s63, 28
  s_cselect_b32 s61, s65, s66
  s_cmp_lt_u32 s63, 13
  s_cselect_b32 s61, s64, s61
  s_add_u32 s61, s61, s62
  s_mul_i32 s61, s61, 288
  s_add_u32 s61, s61, s67
  s_add_u32 s77, s61, 245760
  s_cmp_lt_u32 s63, 27
  s_cselect_b32 s61, s65, s66
  s_cmp_lt_u32 s63, 12
  s_cselect_b32 s61, s64, s61
  s_add_u32 s61, s61, s62
  s_mul_i32 s61, s61, 288
  s_add_u32 s61, s61, s67
  s_add_u32 s78, s61, 328704
  v_add_u32 v49, s75, v48
  s_mov_b32 m0, 0
  s_mov_b32 s30, 1285632
  s_mov_b32 s31, 0x20000
  s_mov_b32 s26, 1152000
  s_mov_b32 s27, 0x20000
  s_waitcnt lgkmcnt(0)
  s_mov_b32 s28, s6
  s_mov_b32 s29, s7
  s_cmp_eq_u32 s55, 9
  s_cbranch_scc1 L_spare
  s_cmp_eq_u32 s59, 0
  s_cbranch_scc0 L_g1
  buffer_load_dwordx4 v48, s[28:31], s74 offen offset:0  lds
  buffer_load_dwordx4 v48, s[28:31], s76 offen offset:2048  lds
  buffer_load_dwordx4 v48, s[28:31], s77 offen offset:3072  lds
  s_mov_b32 m0, 1024
  s_nop 0
  buffer_load_dwordx4 v49, s[28:31], 0 offen  lds
  buffer_load_dwordx4 v48, s[28:31], s78 offen offset:3072  lds
L_g1:
  s_add_u32 s24, s4, s68
  s_addc_u32 s25, s5, 0
  s_mov_b32 m0, s89
  s_movk_i32 s62, 2
L_x1:
  buffer_load_dwordx4 v219, s[24:27], 0 offen  lds
  s_cmp_eq_u32 m0, s90
  s_cselect_b32 s61, 4294956032, s91
  s_add_u32 m0, m0, s61
  s_mul_i32 s61, s61, 9
  v_add_u32 v219, s61, v219
  s_sub_u32 s62, s62, 1
  s_cmp_lg_u32 s62, 0
  s_cbranch_scc1 L_x1
  s_mov_b32 s89, m0
  s_load_dword s60, s[22:23], 0
  s_mul_i32 s21, s79, 5376
  s_add_u32 s21, s21, 196608
  s_lshl_b32 s61, s79, 2
  s_add_u32 s61, s61, s59
  s_mul_i32 s61, s61, 10
  v_min_u32 v240, 9, v1
  v_add_lshl_u32 v240, v240, s61, 7
  s_mov_b32 s32, s22
  s_mov_b32 s33, s23
  s_mov_b32 s34, 268435456
  s_mov_b32 s35, 0x20000
  s_mov_b32 s48, s8
  s_mov_b32 s49, s9
  s_mov_b32 s50, 1285632
  s_mov_b32 s51, 0x20000
  buffer_load_dword v241, v240, s[48:51], 0 offen
  s_mov_b32 s36, s12
  s_mov_b32 s37, s13
  s_mov_b32 s38, 41472
  s_mov_b32 s39, 0x20000
  s_mov_b32 s40, s16
  s_mov_b32 s41, s17
  s_mov_b32 s42, 41472
  s_mov_b32 s43, 0x20000
  s_mov_b32 s44, s18
  s_mov_b32 s45, s19
  s_mov_b32 s46, 4608000
  s_mov_b32 s47, 0x20000
  v_and_b32 v46, 15, v1
  v_lshrrev_b32 v47, 4, v1
  v_mul_u32_u24 v48, 704, v46
  v_lshl_add_u32 v48, v47, 4, v48
  s_mul_i32 s22, s59, 36864
  v_add_u32 v5, s22, v48
  s_add_u32 s88, s22, 24576
  s_lshl_b32 s61, s59, 8
  s_add_u32 s61, s61, 147456
  v_add_u32 v7, s61, v48
  s_lshl_b32 s61, s59, 6
  s_add_u32 s61, s61, 256
  v_add_u32 v218, s61, v227
  s_mul_i32 s61, s59, 3072
  s_add_u32 s3, s61, 147456
  s_mul_i32 s61, s61, 9
  s_sub_u32 s61, s61, 64
  v_add_u32 v227, s61, v227
  v_lshlrev_b32 v48, 5, v47
  v_xor_b32 v48, v48, v2
  v_add_u32 v8, s22, v48
  v_and_or_b32 v51, v1, 12, v47
  v_and_b32 v52, 3, v1
  s_mul_i32 s62, s59, 3
  s_min_u32 s62, s62, 8
  s_lshl_b32 s61, s62, 10
  v_mul_u32_u24 v48, 18, v52
  v_xor_b32 v48, v48, v51
  v_lshl_add_u32 v9, v48, 4, s61
  v_add_u32 v12, 73728, v9
  v_mul_u32_u24 v48, 11, v51
  v_add_u32 v48, s62, v48
  s_mul_i32 s61, s58, 144
  s_sub_u32 s61, s61, 15
  s_movk_i32 s63, 2000
  v_lshrrev_b32 v50, 1, v52
  v_lshl_add_u32 v50, v52, 1, v50
  v_and_b32 v50, 3, v50
  v_lshlrev_b32 v50, 3, v50
  v_add_u32 v50, 147456, v50
  v_lshrrev_b32 v49, 3, v48
  v_add_u32 v49, v49, v48
  v_lshl_add_u32 v220, v49, 5, v50
  v_add_u32 v49, s61, v48
  v_cmp_gt_u32_e64 s[74:75], s63, v49
  v_add_u32 v48, 1, v48
  v_lshrrev_b32 v49, 3, v48
  v_add_u32 v49, v49, v48
  v_lshl_add_u32 v221, v49, 5, v50
  v_add_u32 v49, s61, v48
  v_cmp_gt_u32_e64 s[76:77], s63, v49
  v_add_u32 v48, 1, v48
  v_lshrrev_b32 v49, 3, v48
  v_add_u32 v49, v49, v48
  v_lshl_add_u32 v222, v49, 5, v50
  v_add_u32 v49, s61, v48
  v_cmp_gt_u32_e64 s[78:79], s63, v49
  v_lshrrev_b32 v48, 2, v1
  v_mul_u32_u24 v48, 288, v48
  v_and_b32 v49, 3, v1
  v_lshl_add_u32 v18, v49, 3, v48
  v_add_u32 v19, 73728, v18
  s_mul_i32 s61, s55, 28
  s_add_u32 s61, s61, s59
  s_mul_i32 s70, s61, 5376
  s_add_u32 s70, s70, 196608
  s_mul_i32 s81, s54, 6144
  s_add_u32 s81, s81, 131072
  s_mov_b32 s98, 0xbdd2d3e8
  s_mov_b32 s99, 0xc0135761
  s_mov_b32 s100, 0x3eb17218
  s_mov_b32 s101, 0x3eb17218
  v_add_u32 v3, 4096, v2
  v_lshlrev_b32 v4, 2, v1
  v_add_u32 v4, 5120, v4
  v_lshlrev_b32 v48, 8, v47
  v_lshl_add_u32 v48, v46, 3, v48
  v_mov_b32 v54, v48
  s_waitcnt lgkmcnt(0)
  s_mul_i32 s60, s60, 1664525
  s_add_u32 s60, s60, 1013904223
  s_barrier
  s_cmp_eq_u32 s59, 0
  s_cbranch_scc1 L_p0
  s_mov_b64 exec, 0
  s_cmp_eq_u32 s59, 1
  s_cbranch_scc1 L_pad1
  s_cmp_eq_u32 s59, 2
  s_cbranch_scc1 L_pad2
  s_branch L_pad3
L_home:
  s_mov_b64 exec, -1
  s_branch L_p1
L_p0:
  s_waitcnt vmcnt(3)
  ds_read_b64_tr_b16 v[56:57], v54 offset:0
  ds_read_b64_tr_b16 v[58:59], v54 offset:128
  ds_read_b64_tr_b16 v[60:61], v54 offset:1024
  ds_read_b64_tr_b16 v[62:63], v54 offset:1152
  ds_read_b64_tr_b16 v[64:65], v54 offset:2048
  ds_read_b64_tr_b16 v[66:67], v54 offset:2176
  ds_read_b64_tr_b16 v[68:69], v54 offset:3072
  ds_read_b64_tr_b16 v[70:71], v54 offset:3200
  ds_read_b64_tr_b16 v[72:73], v54 offset:4096
  ds_read_b64_tr_b16 v[74:75], v54 offset:4224
  s_waitcnt lgkmcnt(8)
  buffer_store_dwordx4 v[56:59], v2, s[32:35], s21 offen offset:0 sc1
  v_add3_u32 v33, v56, v57, s60
  v_add3_u32 v33, v58, v59, v33
  s_waitcnt lgkmcnt(6)
  buffer_store_dwordx4 v[60:63], v2, s[32:35], s21 offen offset:1024 sc1
  v_add3_u32 v33, v60, v61, v33
  v_add3_u32 v33, v62, v63, v33
  s_waitcnt lgkmcnt(4)
  buffer_store_dwordx4 v[64:67], v2, s[32:35], s21 offen offset:2048 sc1
  v_add3_u32 v33, v64, v65, v33
  v_add3_u32 v33, v66, v67, v33
  s_waitcnt lgkmcnt(2)
  buffer_store_dwordx4 v[68:71], v2, s[32:35], s21 offen offset:3072 sc1
  v_add3_u32 v33, v68, v69, v33
  v_add3_u32 v33, v70, v71, v33
  s_waitcnt lgkmcnt(0)
  buffer_store_dwordx4 v[72:75], v3, s[32:35], s21 offen offset:0 sc1
  v_add3_u32 v33, v72, v73, v33
  v_add3_u32 v33, v74, v75, v33
  buffer_store_dword v33, v4, s[32:35], s21 offen sc1
L_p1:
  s_barrier
  s_mov_b32 m0, s89
  s_movk_i32 s62, 10
L_x2:
  buffer_load_dwordx4 v219, s[24:27], 0 offen  lds
  s_cmp_eq_u32 m0, s90
  s_cselect_b32 s61, 4294956032, s91
  s_add_u32 m0, m0, s61
  s_mul_i32 s61, s61, 9
  v_add_u32 v219, s61, v219
  s_sub_u32 s62, s62, 1
  s_cmp_lg_u32 s62, 0
  s_cbranch_scc1 L_x2
  s_mov_b32 s89, m0
  s_add_u32 s90, s88, 9216
  s_movk_i32 s91, -9216
  s_and_b32 s61, s55, 3
  s_mul_i32 s61, s61, 3072
  s_add_u32 s88, s88, s61
  s_mul_i32 s61, s61, 9
  v_add_u32 v218, s61, v218
  s_waitcnt vmcnt(9)
  buffer_load_dwordx4 v[142:145], v2, s[32:35], s70 offen offset:0 sc1
  buffer_load_dwordx4 v[146:149], v2, s[32:35], s70 offen offset:1024 sc1
  buffer_load_dwordx4 v[150:153], v2, s[32:35], s70 offen offset:2048 sc1
  buffer_load_dwordx4 v[154:157], v2, s[32:35], s70 offen offset:3072 sc1
  buffer_load_dwordx4 v[158:161], v3, s[32:35], s70 offen offset:0 sc1
  buffer_load_dword v202, v4, s[32:35], s70 offen sc1
  s_waitcnt vmcnt(6)
  ds_read_b128 v[46:49], v5 offset:12288
  ds_read_b128 v[50:53], v5 offset:12352
  ds_read_b128 v[54:57], v5 offset:12416
  ds_read_b128 v[58:61], v5 offset:12480
  ds_read_b128 v[62:65], v5 offset:12544
  ds_read_b128 v[66:69], v5 offset:12608
  ds_read_b128 v[70:73], v5 offset:12672
  ds_read_b128 v[74:77], v5 offset:12736
  ds_read_b128 v[78:81], v5 offset:12800
  ds_read_b128 v[82:85], v5 offset:12864
  ds_read_b128 v[86:89], v5 offset:12928
  s_add_u32 s71, s70, 21504
  buffer_load_dwordx4 v[162:165], v2, s[32:35], s71 offen offset:0 sc1
  buffer_load_dwordx4 v[166:169], v2, s[32:35], s71 offen offset:1024 sc1
  buffer_load_dwordx4 v[170:173], v2, s[32:35], s71 offen offset:2048 sc1
  buffer_load_dwordx4 v[174:177], v2, s[32:35], s71 offen offset:3072 sc1
  buffer_load_dwordx4 v[178:181], v3, s[32:35], s71 offen offset:0 sc1
  buffer_load_dword v203, v4, s[32:35], s71 offen sc1
  s_waitcnt vmcnt(11) lgkmcnt(0)
  v_mfma_f32_16x16x32_bf16 a[144:147], v[142:145], v[46:49], 0
  s_add_u32 s71, s70, 43008
  ds_read_b128 v[90:93], v5 offset:12992
  v_mfma_f32_16x16x32_bf16 a[148:151], v[142:145], v[50:53], 0
  buffer_load_dwordx4 v[182:185], v2, s[32:35], s71 offen offset:0 sc1
  v_mfma_f32_16x16x32_bf16 a[152:155], v[142:145], v[54:57], 0
  v_and_b32 v232, 15, v1
  v_lshrrev_b32 v233, 4, v1
  v_mfma_f32_16x16x32_bf16 a[156:159], v[142:145], v[58:61], 0
  v_mov_b32 v237, 2147483648
  s_mul_i32 s61, s55, 4608
  v_mfma_f32_16x16x32_bf16 a[160:163], v[142:145], v[62:65], 0
  buffer_load_dwordx4 v[186:189], v2, s[32:35], s71 offen offset:1024 sc1
  v_mfma_f32_16x16x32_bf16 a[164:167], v[142:145], v[66:69], 0
  s_mul_i32 s62, s59, 331776
  s_add_u32 s61, s61, s62
  v_add_u32 v206, s61, v2
  v_mfma_f32_16x16x32_bf16 a[168:171], v[142:145], v[70:73], 0
  ds_read_b128 v[94:97], v5 offset:13056
  v_lshrrev_b32 v234, 5, v1
  v_mfma_f32_16x16x32_bf16 a[172:175], v[142:145], v[74:77], 0
  v_mul_u32_u24 v234, 36864, v234
  v_add3_u32 v207, v234, v3, s61
  v_mfma_f32_16x16x32_bf16 a[176:179], v[142:145], v[78:81], 0
  buffer_load_dwordx4 v[190:193], v2, s[32:35], s71 offen offset:2048 sc1
  v_mfma_f32_16x16x32_bf16 a[180:183], v[142:145], v[82:85], 0
  v_add_u32 v208, 41984, v206
  v_lshrrev_b32 v234, 3, v234
  v_mfma_f32_16x16x32_bf16 a[184:187], v[142:145], v[86:89], 0
  s_waitcnt vmcnt(13)
  v_bfe_u32 v235, v1, 2, 3
  v_mul_u32_u24 v235, 288, v235
  v_mfma_f32_16x16x32_bf16 a[144:147], v[146:149], v[50:53], a[144:147]
  v_and_b32 v236, 3, v1
  v_lshlrev_b32 v236, 3, v236
  v_mfma_f32_16x16x32_bf16 a[148:151], v[146:149], v[54:57], a[148:151]
  buffer_load_dwordx4 v[194:197], v2, s[32:35], s71 offen offset:3072 sc1
  v_mfma_f32_16x16x32_bf16 a[152:155], v[146:149], v[58:61], a[152:155]
  v_add3_u32 v234, v234, v235, v236
  s_lshl_b32 s61, s59, 6
  v_mfma_f32_16x16x32_bf16 a[156:159], v[146:149], v[62:65], a[156:159]
  v_add_u32 v210, s61, v234
  v_add_u32 v211, 49152, v210
  v_mfma_f32_16x16x32_bf16 a[160:163], v[146:149], v[66:69], a[160:163]
  buffer_load_dwordx4 v[198:201], v3, s[32:35], s71 offen offset:0 sc1
  v_mfma_f32_16x16x32_bf16 a[164:167], v[146:149], v[70:73], a[164:167]
  v_add_u32 v212, 98304, v210
  v_add_u32 v213, s22, v234
  v_mfma_f32_16x16x32_bf16 a[168:171], v[146:149], v[74:77], a[168:171]
  ds_read_b128 v[98:101], v5 offset:13120
  v_mov_b32 v42, -1
  v_mfma_f32_16x16x32_bf16 a[172:175], v[146:149], v[78:81], a[172:175]
  v_mov_b32 v43, -1
  v_mov_b32 v44, -1
  v_mfma_f32_16x16x32_bf16 a[176:179], v[146:149], v[82:85], a[176:179]
  buffer_load_dword v204, v4, s[32:35], s71 offen sc1
  v_mfma_f32_16x16x32_bf16 a[180:183], v[146:149], v[86:89], a[180:183]
  s_waitcnt lgkmcnt(1)
  s_mov_b32 m0, s88
  v_add3_u32 v33, v142, v143, s60
  v_mfma_f32_16x16x32_bf16 a[184:187], v[146:149], v[90:93], a[184:187]
  s_waitcnt vmcnt(15)
  v_add3_u32 v33, v144, v145, v33
  v_add3_u32 v33, v146, v147, v33
  v_mfma_f32_16x16x32_bf16 a[144:147], v[150:153], v[54:57], a[144:147]
  buffer_load_dwordx4 v218, s[24:27], 0 offen  lds
  v_mfma_f32_16x16x32_bf16 a[148:151], v[150:153], v[58:61], a[148:151]
  s_add_u32 m0, s88, 1024
  v_add_u32 v218, 9216, v218
  v_add3_u32 v33, v148, v149, v33
  v_mfma_f32_16x16x32_bf16 a[152:155], v[150:153], v[62:65], a[152:155]
  v_add3_u32 v33, v150, v151, v33
  v_add3_u32 v33, v152, v153, v33
  v_mfma_f32_16x16x32_bf16 a[156:159], v[150:153], v[66:69], a[156:159]
  buffer_load_dwordx4 v218, s[24:27], 0 offen  lds
  v_mfma_f32_16x16x32_bf16 a[160:163], v[150:153], v[70:73], a[160:163]
  s_add_u32 m0, s88, 2048
  v_add_u32 v218, 9216, v218
  v_mov_b32 v45, -1
  v_mfma_f32_16x16x32_bf16 a[164:167], v[150:153], v[74:77], a[164:167]
  s_mul_i32 s73, s56, 165888
  s_waitcnt vmcnt(16)
  v_add3_u32 v33, v154, v155, v33
  v_mfma_f32_16x16x32_bf16 a[168:171], v[150:153], v[78:81], a[168:171]
  s_add_u32 s73, s73, 3145728
  v_add3_u32 v33, v156, v157, v33
  s_lshl_b32 s61, s59, 7
  v_mfma_f32_16x16x32_bf16 a[172:175], v[150:153], v[82:85], a[172:175]
  buffer_load_dwordx4 v218, s[24:27], 0 offen  lds
  v_mfma_f32_16x16x32_bf16 a[176:179], v[150:153], v[86:89], a[176:179]
  s_add_u32 s93, s73, s61
  s_waitcnt vmcnt(16)
  v_add3_u32 v33, v158, v159, v33
  v_mfma_f32_16x16x32_bf16 a[180:183], v[150:153], v[90:93], a[180:183]
  s_lshl_b32 s61, s55, 2
  v_add3_u32 v33, v160, v161, v33
  s_add_u32 s61, s61, s59
  v_mfma_f32_16x16x32_bf16 a[184:187], v[150:153], v[94:97], a[184:187]
  s_lshl_b32 s61, s61, 9
  s_waitcnt vmcnt(15)
  v_cmp_ne_u32 vcc, v33, v202
  s_nop 0
  s_cbranch_vccnz L_r1_0
L_r1_0_back:
  v_mfma_f32_16x16x32_bf16 a[144:147], v[154:157], v[58:61], a[144:147]
  s_add_u32 s61, s61, 147456
  ds_read_b128 v[102:105], v5 offset:13184
  v_mfma_f32_16x16x32_bf16 a[148:151], v[154:157], v[62:65], a[148:151]
  s_add_u32 s19, s73, s61
  v_lshlrev_b32 v234, 5, v232
  v_lshl_add_u32 v17, v233, 3, v234
  v_mfma_f32_16x16x32_bf16 a[152:155], v[154:157], v[66:69], a[152:155]
  s_cmp_eq_u32 s88, s90
  s_cselect_b32 s89, s91, 3072
  s_add_u32 s88, s88, s89
  s_mov_b32 m0, s88
  s_mul_i32 s89, s89, 9
  s_sub_u32 s89, s89, 18432
  v_add_u32 v218, s89, v218
  v_mfma_f32_16x16x32_bf16 a[156:159], v[154:157], v[70:73], a[156:159]
  buffer_load_dwordx4 v218, s[24:27], 0 offen  lds
  v_mfma_f32_16x16x32_bf16 a[160:163], v[154:157], v[74:77], a[160:163]
  s_add_u32 m0, s88, 1024
  v_add_u32 v218, 9216, v218
  v_lshrrev_b32 v234, 1, v232
  v_mfma_f32_16x16x32_bf16 a[164:167], v[154:157], v[78:81], a[164:167]
  s_waitcnt vmcnt(15)
  v_add3_u32 v33, v162, v163, s60
  v_add3_u32 v33, v164, v165, v33
  v_mfma_f32_16x16x32_bf16 a[168:171], v[154:157], v[82:85], a[168:171]
  buffer_load_dwordx4 v218, s[24:27], 0 offen  lds
  v_mfma_f32_16x16x32_bf16 a[172:175], v[154:157], v[86:89], a[172:175]
  s_add_u32 m0, s88, 2048
  v_add_u32 v218, 9216, v218
  v_cmp_le_u32_e64 s[20:21], s55, v234
  v_mfma_f32_16x16x32_bf16 a[176:179], v[154:157], v[90:93], a[176:179]
  s_waitcnt vmcnt(15)
  v_add3_u32 v33, v166, v167, v33
  v_add3_u32 v33, v168, v169, v33
  v_mfma_f32_16x16x32_bf16 a[180:183], v[154:157], v[94:97], a[180:183]
  s_waitcnt lgkmcnt(1)
  s_waitcnt vmcnt(14)
  v_add3_u32 v33, v170, v171, v33
  v_mfma_f32_16x16x32_bf16 a[184:187], v[154:157], v[98:101], a[184:187]
  buffer_load_dwordx4 v218, s[24:27], 0 offen  lds
  v_mfma_f32_16x16x32_bf16 a[144:147], v[158:161], v[62:65], a[144:147]
  s_cmp_eq_u32 s88, s90
  s_cselect_b32 s89, s91, 3072
  s_add_u32 s88, s88, s89
  s_mov_b32 m0, s88
  s_mul_i32 s89, s89, 9
  s_sub_u32 s89, s89, 18432
  v_add_u32 v218, s89, v218
  v_mfma_f32_16x16x32_bf16 a[148:151], v[158:161], v[66:69], a[148:151]
  v_add3_u32 v33, v172, v173, v33
  v_cndmask_b32_e64 v236, 0, 1, s[20:21]
  v_mfma_f32_16x16x32_bf16 a[152:155], v[158:161], v[70:73], a[152:155]
  buffer_load_dwordx4 v218, s[24:27], 0 offen  lds
  v_mfma_f32_16x16x32_bf16 a[156:159], v[158:161], v[74:77], a[156:159]
  s_add_u32 m0, s88, 1024
  v_add_u32 v218, 9216, v218
  v_add_u32 v234, v234, v236
  v_mfma_f32_16x16x32_bf16 a[160:163], v[158:161], v[78:81], a[160:163]
  s_waitcnt vmcnt(15)
  v_add3_u32 v33, v174, v175, v33
  v_add3_u32 v33, v176, v177, v33
  v_mfma_f32_16x16x32_bf16 a[164:167], v[158:161], v[82:85], a[164:167]
  buffer_load_dwordx4 v218, s[24:27], 0 offen  lds
  v_mfma_f32_16x16x32_bf16 a[168:171], v[158:161], v[86:89], a[168:171]
  s_add_u32 m0, s88, 2048
  v_add_u32 v218, 9216, v218
  v_lshl_add_u32 v238, v236, 1, v232
  v_mfma_f32_16x16x32_bf16 a[172:175], v[158:161], v[90:93], a[172:175]
  s_waitcnt vmcnt(15)
  v_add3_u32 v33, v178, v179, v33
  v_add3_u32 v33, v180, v181, v33
  v_mfma_f32_16x16x32_bf16 a[176:179], v[158:161], v[94:97], a[176:179]
  s_waitcnt vmcnt(14)
  v_cmp_ne_u32 vcc, v33, v203
  s_nop 0
  s_cbranch_vccnz L_r1_1
L_r1_1_back:
  v_mfma_f32_16x16x32_bf16 a[180:183], v[158:161], v[98:101], a[180:183]
  s_waitcnt lgkmcnt(0)
  ds_read_b128 v[106:109], v5 offset:13248
  v_mfma_f32_16x16x32_bf16 a[184:187], v[158:161], v[102:105], a[184:187]
  buffer_load_dwordx4 v218, s[24:27], 0 offen  lds
  v_mfma_f32_16x16x32_bf16 a[144:147], v[162:165], v[66:69], a[144:147]
  s_cmp_eq_u32 s88, s90
  s_cselect_b32 s89, s91, 3072
  s_add_u32 s88, s88, s89
  s_mov_b32 m0, s88
  s_mul_i32 s89, s89, 9
  s_sub_u32 s89, s89, 18432
  v_add_u32 v218, s89, v218
  v_mfma_f32_16x16x32_bf16 a[148:151], v[162:165], v[70:73], a[148:151]
  buffer_load_dwordx4 v218, s[24:27], 0 offen  lds
  v_mfma_f32_16x16x32_bf16 a[152:155], v[162:165], v[74:77], a[152:155]
  s_add_u32 m0, s88, 1024
  v_add_u32 v218, 9216, v218
  v_add3_u32 v236, v236, s55, -1
  v_mfma_f32_16x16x32_bf16 a[156:159], v[162:165], v[78:81], a[156:159]
  ds_read_b128 v[110:113], v5 offset:13312
  v_and_b32 v235, 1, v236
  v_mfma_f32_16x16x32_bf16 a[160:163], v[162:165], v[82:85], a[160:163]
L_pad1:
  s_cbranch_execz L_pad4
  v_lshrrev_b32 v236, 1, v236
  v_lshl_add_u32 v234, v234, 2, v236
  v_mfma_f32_16x16x32_bf16 a[164:167], v[162:165], v[86:89], a[164:167]
  buffer_load_dwordx4 v218, s[24:27], 0 offen  lds
  v_mfma_f32_16x16x32_bf16 a[168:171], v[162:165], v[90:93], a[168:171]
  s_add_u32 m0, s88, 2048
  v_add_u32 v218, 9216, v218
  v_lshl_add_u32 v234, v234, 3, v235
  v_mfma_f32_16x16x32_bf16 a[172:175], v[162:165], v[94:97], a[172:175]
  ds_read_b128 v[114:117], v5 offset:13376
  v_and_b32 v235, 1, v232
  v_mfma_f32_16x16x32_bf16 a[176:179], v[162:165], v[98:101], a[176:179]
  v_lshl_add_u32 v234, v234, 3, v235
  v_lshl_add_u32 v234, v234, 2, v233
  v_mfma_f32_16x16x32_bf16 a[180:183], v[162:165], v[102:105], a[180:183]
  s_waitcnt lgkmcnt(2)
  v_lshlrev_b32 v16, 4, v234
  v_mul_u32_u24 v234, 288, v238
  v_mfma_f32_16x16x32_bf16 a[184:187], v[162:165], v[106:109], a[184:187]
  buffer_load_dwordx4 v218, s[24:27], 0 offen  lds
  v_mfma_f32_16x16x32_bf16 a[144:147], v[166:169], v[70:73], a[144:147]
  s_add_u32 s71, s70, 64512
  v_lshl_add_u32 v234, v233, 4, v234
  v_add_u32 v11, 147456, v234
  v_mfma_f32_16x16x32_bf16 a[148:151], v[166:169], v[74:77], a[148:151]
  s_mul_i32 s61, s59, 288
  v_add_u32 v223, s61, v11
  s_mul_i32 s61, s55, 576
  v_mfma_f32_16x16x32_bf16 a[152:155], v[166:169], v[78:81], a[152:155]
  buffer_load_dwordx4 v[142:145], v2, s[32:35], s71 offen offset:0 sc1
  v_mfma_f32_16x16x32_bf16 a[156:159], v[166:169], v[82:85], a[156:159]
  s_add_u32 s61, s61, 147456
  v_lshl_add_u32 v236, v233, 4, s61
  v_and_b32 v239, 7, v1
  v_mfma_f32_16x16x32_bf16 a[160:163], v[166:169], v[86:89], a[160:163]
  v_lshrrev_b32 v234, 1, v232
  v_and_b32 v234, 4, v234
  v_mfma_f32_16x16x32_bf16 a[164:167], v[166:169], v[90:93], a[164:167]
  v_xor_b32 v238, v234, v239
  v_add_u32 v234, 0, v238
  v_mfma_f32_16x16x32_bf16 a[168:171], v[166:169], v[94:97], a[168:171]
  ds_read_b128 v[118:121], v5 offset:13440
  v_lshrrev_b32 v235, 2, v234
  v_mfma_f32_16x16x32_bf16 a[172:175], v[166:169], v[98:101], a[172:175]
  buffer_load_dwordx4 v[146:149], v2, s[32:35], s71 offen offset:1024 sc1
  v_mfma_f32_16x16x32_bf16 a[176:179], v[166:169], v[102:105], a[176:179]
  v_lshl_add_u32 v234, v234, 1, v235
  v_lshl_add_u32 v6, v234, 5, v236
  v_mfma_f32_16x16x32_bf16 a[180:183], v[166:169], v[106:109], a[180:183]
  s_waitcnt lgkmcnt(1)
  v_add_u32 v234, 1, v238
  v_lshrrev_b32 v235, 2, v234
  v_mfma_f32_16x16x32_bf16 a[184:187], v[166:169], v[110:113], a[184:187]
  buffer_load_dwordx4 v[150:153], v2, s[32:35], s71 offen offset:2048 sc1
  v_mfma_f32_16x16x32_bf16 a[144:147], v[170:173], v[74:77], a[144:147]
  v_lshl_add_u32 v234, v234, 1, v235
  v_lshl_add_u32 v10, v234, 5, v236
  v_mfma_f32_16x16x32_bf16 a[148:151], v[170:173], v[78:81], a[148:151]
  v_add_u32 v234, 2, v238
  v_lshrrev_b32 v235, 2, v234
  v_mfma_f32_16x16x32_bf16 a[152:155], v[170:173], v[82:85], a[152:155]
  v_lshl_add_u32 v234, v234, 1, v235
  v_lshl_add_u32 v20, v234, 5, v236
  v_mfma_f32_16x16x32_bf16 a[156:159], v[170:173], v[86:89], a[156:159]
  buffer_load_dwordx4 v[154:157], v2, s[32:35], s71 offen offset:3072 sc1
  v_mfma_f32_16x16x32_bf16 a[160:163], v[170:173], v[90:93], a[160:163]
  v_add_u32 v234, 3, v238
  v_lshrrev_b32 v235, 2, v234
  v_mfma_f32_16x16x32_bf16 a[164:167], v[170:173], v[94:97], a[164:167]
  v_lshl_add_u32 v234, v234, 1, v235
  v_lshl_add_u32 v21, v234, 5, v236
  v_mfma_f32_16x16x32_bf16 a[168:171], v[170:173], v[98:101], a[168:171]
  s_lshl_b32 s61, s59, 12
  ds_read_b128 v[122:125], v5 offset:13504
  v_mfma_f32_16x16x32_bf16 a[172:175], v[170:173], v[102:105], a[172:175]
  buffer_load_dwordx4 v[158:161], v3, s[32:35], s71 offen offset:0 sc1
  v_mfma_f32_16x16x32_bf16 a[176:179], v[170:173], v[106:109], a[176:179]
  s_add_u32 s61, s61, 94208
  v_add_u32 v13, s61, v2
  s_lshl_b32 s62, s59, 10
  v_mfma_f32_16x16x32_bf16 a[180:183], v[170:173], v[110:113], a[180:183]
  s_add_u32 s61, s62, 94208
  v_add_u32 v14, s61, v2
  s_lshl_b32 s61, s55, 14
  v_mfma_f32_16x16x32_bf16 a[184:187], v[170:173], v[114:117], a[184:187]
  buffer_load_dword v202, v4, s[32:35], s71 offen sc1
  v_mfma_f32_16x16x32_bf16 a[144:147], v[174:177], v[78:81], a[144:147]
  s_add_u32 s61, s61, s62
  s_add_u32 s72, s73, s61
  s_movk_i32 s61, 25600
  v_mfma_f32_16x16x32_bf16 a[148:151], v[174:177], v[82:85], a[148:151]
  v_lshl_add_u32 v234, v239, 4, s61
  v_lshl_add_u32 v30, v233, 7, v234
  v_mfma_f32_16x16x32_bf16 a[152:155], v[174:177], v[86:89], a[152:155]
  s_add_u32 s61, s62, 131072
  v_lshl_add_u32 v234, v238, 4, s61
  v_lshl_add_u32 v15, v233, 7, v234
  v_mfma_f32_16x16x32_bf16 a[156:159], v[174:177], v[90:93], a[156:159]
  s_add_u32 m0, s22, 0
  s_mov_b32 s92, 0
  v_bfe_u32 v238, v1, 3, 1
  v_mfma_f32_16x16x32_bf16 a[160:163], v[174:177], v[94:97], a[160:163]
  v_bfe_u32 v235, v1, 2, 1
  v_and_b32 v236, 3, v1
  v_mfma_f32_16x16x32_bf16 a[164:167], v[174:177], v[98:101], a[164:167]
  buffer_load_dwordx4 v206, s[48:51], s92 offen offset:0 lds
  v_mfma_f32_16x16x32_bf16 a[168:171], v[174:177], v[102:105], a[168:171]
  s_waitcnt vmcnt(24)
  v_add3_u32 v33, v182, v183, s60
  v_add3_u32 v33, v184, v185, v33
  v_mfma_f32_16x16x32_bf16 a[172:175], v[174:177], v[106:109], a[172:175]
  s_waitcnt vmcnt(23)
  v_add3_u32 v33, v186, v187, v33
  v_add3_u32 v33, v188, v189, v33
  v_mfma_f32_16x16x32_bf16 a[176:179], v[174:177], v[110:113], a[176:179]
  s_waitcnt vmcnt(22)
  v_add3_u32 v33, v190, v191, v33
  v_add3_u32 v33, v192, v193, v33
  v_mfma_f32_16x16x32_bf16 a[180:183], v[174:177], v[114:117], a[180:183]
  s_waitcnt lgkmcnt(0)
  s_waitcnt vmcnt(21)
  v_add3_u32 v33, v194, v195, v33
  v_mfma_f32_16x16x32_bf16 a[184:187], v[174:177], v[118:121], a[184:187]
  buffer_load_dwordx4 v206, s[48:51], s92 offen offset:1024 lds
  v_mfma_f32_16x16x32_bf16 a[144:147], v[178:181], v[82:85], a[144:147]
  v_add3_u32 v33, v196, v197, v33
  v_lshrrev_b32 v234, 5, v1
  v_mfma_f32_16x16x32_bf16 a[148:151], v[178:181], v[86:89], a[148:151]
  s_waitcnt vmcnt(21)
  v_add3_u32 v33, v198, v199, v33
  v_add3_u32 v33, v200, v201, v33
  v_mfma_f32_16x16x32_bf16 a[152:155], v[178:181], v[90:93], a[152:155]
  buffer_load_dwordx4 v206, s[48:51], s92 offen offset:2048 lds
  v_mfma_f32_16x16x32_bf16 a[156:159], v[178:181], v[94:97], a[156:159]
  ds_read_b128 v[126:129], v5 offset:13568
  v_lshl_add_u32 v234, v234, 1, v238
  v_mfma_f32_16x16x32_bf16 a[160:163], v[178:181], v[98:101], a[160:163]
  s_waitcnt vmcnt(21)
  v_cmp_ne_u32 vcc, v33, v204
  s_nop 0
  s_cbranch_vccnz L_r1_2
L_r1_2_back:
  v_mfma_f32_16x16x32_bf16 a[164:167], v[178:181], v[102:105], a[164:167]
  v_mul_u32_u24 v24, 288, v235
  v_lshl_add_u32 v24, v236, 4, v24
  v_mfma_f32_16x16x32_bf16 a[168:171], v[178:181], v[106:109], a[168:171]
  buffer_load_dwordx4 v206, s[48:51], s92 offen offset:3072 lds
  v_mfma_f32_16x16x32_bf16 a[172:175], v[178:181], v[110:113], a[172:175]
  ds_read_b128 v[130:133], v5 offset:13632
  v_lshl_add_u32 v24, v234, 6, v24
  v_mfma_f32_16x16x32_bf16 a[176:179], v[178:181], v[114:117], a[176:179]
  s_add_u32 s71, s70, 86016
  v_lshl_add_u32 v235, v236, 1, v235
  v_lshl_add_u32 v235, v234, 4, v235
  v_mfma_f32_16x16x32_bf16 a[180:183], v[178:181], v[118:121], a[180:183]
  v_bfe_u32 v234, v1, 4, 1
  v_lshl_add_u32 v24, v234, 3, v24
  v_mfma_f32_16x16x32_bf16 a[184:187], v[178:181], v[122:125], a[184:187]
  v_lshl_add_u32 v235, v234, 3, v235
  s_lshl_b32 s63, s59, 4
  v_mfma_f32_16x16x32_bf16 a[144:147], v[182:185], v[86:89], a[144:147]
  buffer_load_dwordx4 v[162:165], v2, s[32:35], s71 offen offset:0 sc1
  v_mfma_f32_16x16x32_bf16 a[148:151], v[182:185], v[90:93], a[148:151]
  s_add_u32 m0, s3, 0
  s_add_u32 s63, s63, 131072
  v_lshl_add_u32 v31, v235, 6, s63
  v_mfma_f32_16x16x32_bf16 a[152:155], v[182:185], v[94:97], a[152:155]
  v_and_b32 v234, 6, v1
  v_add_u32 v234, v234, v238
  v_mfma_f32_16x16x32_bf16 a[156:159], v[182:185], v[98:101], a[156:159]
  buffer_load_dwordx4 v227, s[24:27], 0 offen  lds
  v_mfma_f32_16x16x32_bf16 a[160:163], v[182:185], v[102:105], a[160:163]
  s_add_u32 m0, s3, 1024
  v_add_u32 v227, 9216, v227
  v_lshl_add_u32 v234, v233, 4, v234
  v_mfma_f32_16x16x32_bf16 a[164:167], v[182:185], v[106:109], a[164:167]
  v_and_b32 v235, 1, v1
  v_lshl_add_u32 v234, v234, 4, v235
  v_mfma_f32_16x16x32_bf16 a[168:171], v[182:185], v[110:113], a[168:171]
  ds_read_b128 v[134:137], v5 offset:13696
  s_waitcnt vmcnt(12)
  v_mfma_f32_16x16x32_bf16 a[172:175], v[182:185], v[114:117], a[172:175]
  buffer_load_dwordx4 v[166:169], v2, s[32:35], s71 offen offset:1024 sc1
  v_mfma_f32_16x16x32_bf16 a[176:179], v[182:185], v[118:121], a[176:179]
  ds_read_b128 v[54:57], v5 offset:24576
  v_lshl_add_u32 v205, v234, 2, s63
  v_mfma_f32_16x16x32_bf16 a[180:183], v[182:185], v[122:125], a[180:183]
  s_waitcnt lgkmcnt(2)
  s_mul_i32 s61, s59, 640
  s_add_u32 s61, s61, 139264
  v_mfma_f32_16x16x32_bf16 a[184:187], v[182:185], v[126:129], a[184:187]
  ds_read_b128 v[58:61], v5 offset:24640
  v_add_u32 v24, s61, v24
  v_mfma_f32_16x16x32_bf16 a[144:147], v[186:189], v[90:93], a[144:147]
  buffer_load_dwordx4 v227, s[24:27], 0 offen  lds
  v_mfma_f32_16x16x32_bf16 a[148:151], v[186:189], v[94:97], a[148:151]
  s_lshl_b32 s63, s59, 9
  s_add_u32 m0, s3, 2048
  v_add_u32 v227, 9216, v227
  v_mfma_f32_16x16x32_bf16 a[152:155], v[186:189], v[98:101], a[152:155]
  s_lshl_b32 s64, s55, 6
  s_add_u32 s63, s63, s64
  s_add_u32 s63, s63, 147392
  v_mfma_f32_16x16x32_bf16 a[156:159], v[186:189], v[102:105], a[156:159]
  v_lshl_add_u32 v234, v232, 2, s63
  v_lshl_add_u32 v234, v233, 11, v234
  v_mfma_f32_16x16x32_bf16 a[160:163], v[186:189], v[106:109], a[160:163]
  buffer_load_dwordx4 v[170:173], v2, s[32:35], s71 offen offset:2048 sc1
  v_mfma_f32_16x16x32_bf16 a[164:167], v[186:189], v[110:113], a[164:167]
  ds_read_b128 v[62:65], v5 offset:24704
  v_add_u32 v235, 2112, v234
  v_mfma_f32_16x16x32_bf16 a[168:171], v[186:189], v[114:117], a[168:171]
  v_cmp_le_u32_e64 s[20:21], s55, v233
  v_mfma_f32_16x16x32_bf16 a[172:175], v[186:189], v[118:121], a[172:175]
  buffer_load_dwordx4 v227, s[24:27], 0 offen  lds
  v_mfma_f32_16x16x32_bf16 a[176:179], v[186:189], v[122:125], a[176:179]
  ds_read_b128 v[138:141], v5 offset:13760
  v_cndmask_b32_e64 v22, v234, v235, s[20:21]
  v_mfma_f32_16x16x32_bf16 a[180:183], v[186:189], v[126:129], a[180:183]
  v_add_u32 v236, 4, v233
  v_cmp_le_u32_e64 s[20:21], s55, v236
  v_mfma_f32_16x16x32_bf16 a[184:187], v[186:189], v[130:133], a[184:187]
  s_add_u32 m0, s22, 4096
  ds_read_b128 v[66:69], v5 offset:24768
  v_mfma_f32_16x16x32_bf16 a[144:147], v[190:193], v[94:97], a[144:147]
  buffer_load_dwordx4 v[174:177], v2, s[32:35], s71 offen offset:3072 sc1
  v_mfma_f32_16x16x32_bf16 a[148:151], v[190:193], v[98:101], a[148:151]
  v_cndmask_b32_e64 v234, v234, v235, s[20:21]
  v_add_u32 v23, 8192, v234
  v_mfma_f32_16x16x32_bf16 a[152:155], v[190:193], v[102:105], a[152:155]
  ds_read_b128 v[70:73], v5 offset:24832
  v_cmp_gt_u32_e64 s[20:21], 32, v1
  v_mfma_f32_16x16x32_bf16 a[156:159], v[190:193], v[106:109], a[156:159]
  v_mul_u32_u24 v234, 288, v238
  v_add_u32 v234, s61, v234
  v_mfma_f32_16x16x32_bf16 a[160:163], v[190:193], v[110:113], a[160:163]
  buffer_load_dwordx4 v[178:181], v3, s[32:35], s71 offen offset:0 sc1
  v_mfma_f32_16x16x32_bf16 a[164:167], v[190:193], v[114:117], a[164:167]
  v_lshl_add_u32 v26, v233, 4, v234
  v_add_u32 v234, 256, v234
  v_mfma_f32_16x16x32_bf16 a[168:171], v[190:193], v[118:121], a[168:171]
  ds_read_b128 v[46:49], v5 offset:13824
  v_lshl_add_u32 v27, v233, 3, v234
  v_mfma_f32_16x16x32_bf16 a[172:175], v[190:193], v[122:125], a[172:175]
  v_lshl_add_u32 v234, v239, 2, v234
  v_lshl_add_u32 v234, v233, 1, v234
  v_mfma_f32_16x16x32_bf16 a[176:179], v[190:193], v[126:129], a[176:179]
  buffer_load_dwordx4 v207, s[48:51], s92 offen offset:0 lds
  v_mfma_f32_16x16x32_bf16 a[180:183], v[190:193], v[130:133], a[180:183]
  s_waitcnt lgkmcnt(3)
  buffer_load_dword v203, v4, s[32:35], s71 offen sc1
  v_mfma_f32_16x16x32_bf16 a[184:187], v[190:193], v[134:137], a[184:187]
  s_add_u32 m0, s22, 5120
  ds_read_b128 v[74:77], v5 offset:24896
  v_mfma_f32_16x16x32_bf16 a[144:147], v[194:197], v[98:101], a[144:147]
  s_add_u32 s61, s61, 512
  v_lshl_add_u32 v235, v1, 1, s61
  v_cndmask_b32_e64 v25, v235, v234, s[20:21]
  v_mfma_f32_16x16x32_bf16 a[148:151], v[194:197], v[102:105], a[148:151]
  s_mul_i32 s66, s58, 9
  ds_read_b128 v[78:81], v5 offset:24960
  v_mfma_f32_16x16x32_bf16 a[152:155], v[194:197], v[106:109], a[152:155]
  buffer_load_dwordx4 v208, s[48:51], s92 offen offset:0 lds
  v_mfma_f32_16x16x32_bf16 a[156:159], v[194:197], v[110:113], a[156:159]
  s_add_u32 s66, s66, s55
  s_lshl_b32 s66, s66, 3
  s_add_u32 s66, s66, s59
  v_mfma_f32_16x16x32_bf16 a[160:163], v[194:197], v[114:117], a[160:163]
  s_mul_i32 s61, s57, 1000
  ds_read_b128 v[82:85], v5 offset:25024
  v_mfma_f32_16x16x32_bf16 a[164:167], v[194:197], v[118:121], a[164:167]
  s_add_u32 s61, s61, s66
  s_waitcnt vmcnt(20)
  v_add3_u32 v33, v142, v143, s60
  v_mfma_f32_16x16x32_bf16 a[168:171], v[194:197], v[122:125], a[168:171]
  buffer_load_dwordx4 v208, s[48:51], s92 offen offset:1024 lds
  v_mfma_f32_16x16x32_bf16 a[172:175], v[194:197], v[126:129], a[172:175]
  s_mul_i32 s61, s61, 2304
  v_add3_u32 v33, v144, v145, v33
  v_mfma_f32_16x16x32_bf16 a[176:179], v[194:197], v[130:133], a[176:179]
  s_cmp_lt_u32 s66, 1000
  s_cselect_b32 s61, s61, 2147483648
  v_lshlrev_b32 v234, 4, v239
  v_mfma_f32_16x16x32_bf16 a[180:183], v[194:197], v[134:137], a[180:183]
  s_waitcnt vmcnt(20)
  v_add3_u32 v33, v146, v147, v33
  v_add3_u32 v33, v148, v149, v33
  v_mfma_f32_16x16x32_bf16 a[184:187], v[194:197], v[138:141], a[184:187]
  buffer_load_dwordx4 v208, s[48:51], s92 offen offset:2048 lds
  v_mfma_f32_16x16x32_bf16 a[144:147], v[198:201], v[102:105], a[144:147]
  s_waitcnt vmcnt(20)
  v_add3_u32 v33, v150, v151, v33
  v_add3_u32 v33, v152, v153, v33
  v_mfma_f32_16x16x32_bf16 a[148:151], v[198:201], v[106:109], a[148:151]
  s_waitcnt vmcnt(19)
  v_add3_u32 v33, v154, v155, v33
  v_add3_u32 v33, v156, v157, v33
  v_mfma_f32_16x16x32_bf16 a[152:155], v[198:201], v[110:113], a[152:155]
  s_waitcnt vmcnt(18)
  v_add3_u32 v33, v158, v159, v33
  v_add3_u32 v33, v160, v161, v33
  v_mfma_f32_16x16x32_bf16 a[156:159], v[198:201], v[114:117], a[156:159]
  buffer_load_dwordx4 v208, s[48:51], s92 offen offset:3072 lds
  v_mfma_f32_16x16x32_bf16 a[160:163], v[198:201], v[118:121], a[160:163]
  s_add_u32 m0, s22, 9216
  s_mov_b32 s92, 82944
  v_mul_u32_u24 v235, 1152, v238
  v_mfma_f32_16x16x32_bf16 a[164:167], v[198:201], v[122:125], a[164:167]
  s_waitcnt vmcnt(18)
  v_cmp_ne_u32 vcc, v33, v202
  s_nop 0
  s_cbranch_vccnz L_r1_3
L_r1_3_back:
  v_mfma_f32_16x16x32_bf16 a[168:171], v[198:201], v[126:129], a[168:171]
  buffer_load_dwordx4 v206, s[48:51], s92 offen offset:0 lds
  v_mfma_f32_16x16x32_bf16 a[172:175], v[198:201], v[130:133], a[172:175]
  ds_read_b128 v[50:53], v5 offset:13888
  v_add_u32 v234, v234, v235
  v_mfma_f32_16x16x32_bf16 a[176:179], v[198:201], v[134:137], a[176:179]
  s_add_u32 s71, s70, 107520
  v_cndmask_b32_e64 v235, 0, 1, s[20:21]
  v_lshl_add_u32 v234, v235, 8, v234
  v_mfma_f32_16x16x32_bf16 a[180:183], v[198:201], v[138:141], a[180:183]
  s_waitcnt lgkmcnt(1)
  ds_read_b128 v[86:89], v5 offset:25088
  v_mfma_f32_16x16x32_bf16 a[184:187], v[198:201], v[46:49], a[184:187]
  buffer_load_dwordx4 v206, s[48:51], s92 offen offset:1024 lds
  v_mfma_f32_16x16x32_bf16 a[144:147], v[142:145], v[106:109], a[144:147]
  ds_read_b128 v[90:93], v5 offset:25152
  v_and_b32 v235, 1, v233
  v_mfma_f32_16x16x32_bf16 a[148:151], v[142:145], v[110:113], a[148:151]
  v_mul_u32_u24 v235, 2304, v235
  v_add3_u32 v29, v234, v235, s22
  v_mfma_f32_16x16x32_bf16 a[152:155], v[142:145], v[114:117], a[152:155]
  buffer_load_dwordx4 v206, s[48:51], s92 offen offset:2048 lds
  v_mfma_f32_16x16x32_bf16 a[156:159], v[142:145], v[118:121], a[156:159]
  ds_read_b128 v[94:97], v5 offset:25216
  v_lshl_add_u32 v234, v235, 2, v234
  v_mfma_f32_16x16x32_bf16 a[160:163], v[142:145], v[122:125], a[160:163]
  v_add_u32 v28, s61, v234
  s_mul_i32 s61, s56, 9
  v_mfma_f32_16x16x32_bf16 a[164:167], v[142:145], v[126:129], a[164:167]
  v_add_u32 v234, s61, v1
  v_add_u32 v235, 243, v1
  v_mfma_f32_16x16x32_bf16 a[168:171], v[142:145], v[130:133], a[168:171]
  buffer_load_dwordx4 v[182:185], v2, s[32:35], s71 offen offset:0 sc1
  v_mfma_f32_16x16x32_bf16 a[172:175], v[142:145], v[134:137], a[172:175]
  ds_read_b128 v[98:101], v5 offset:25280
  v_min_u32 v235, 255, v235
  v_mfma_f32_16x16x32_bf16 a[176:179], v[142:145], v[138:141], a[176:179]
  s_movk_i32 s61, 512
  v_cmp_gt_u32_e64 s[20:21], 9, v1
  v_mfma_f32_16x16x32_bf16 a[180:183], v[142:145], v[46:49], a[180:183]
  s_waitcnt lgkmcnt(3)
  v_cndmask_b32_e64 v234, v235, v234, s[20:21]
  v_add_lshl_u32 v32, v234, s61, 7
  v_mfma_f32_16x16x32_bf16 a[184:187], v[142:145], v[50:53], a[184:187]
  buffer_load_dwordx4 v[186:189], v2, s[32:35], s71 offen offset:1024 sc1
  v_mfma_f32_16x16x32_bf16 a[144:147], v[146:149], v[54:57], a[144:147]
  v_and_b32 v234, 1, v233
  v_lshlrev_b32 v234, 3, v234
  v_mfma_f32_16x16x32_bf16 a[148:151], v[146:149], v[58:61], a[148:151]
  v_sub_u32 v234, v232, v234
  v_and_b32 v235, 1, v234
  v_mfma_f32_16x16x32_bf16 a[152:155], v[146:149], v[62:65], a[152:155]
  buffer_load_dwordx4 v[190:193], v2, s[32:35], s71 offen offset:2048 sc1
  v_mfma_f32_16x16x32_bf16 a[156:159], v[146:149], v[66:69], a[156:159]
  v_lshlrev_b32 v235, 4, v235
  v_mov_b32 v236, 0x3f80
  v_mfma_f32_16x16x32_bf16 a[160:163], v[146:149], v[70:73], a[160:163]
  v_lshlrev_b32 v235, v235, v236
  v_lshrrev_b32 v234, 1, v234
  v_mfma_f32_16x16x32_bf16 a[164:167], v[146:149], v[74:77], a[164:167]
  v_cmp_eq_u32_e64 s[20:21], 0, v234
  v_mfma_f32_16x16x32_bf16 a[168:171], v[146:149], v[78:81], a[168:171]
  buffer_load_dwordx4 v[194:197], v2, s[32:35], s71 offen offset:3072 sc1
  v_mfma_f32_16x16x32_bf16 a[172:175], v[146:149], v[82:85], a[172:175]
  ds_read_b128 v[102:105], v5 offset:25344
  v_cndmask_b32_e64 v34, 0, v235, s[20:21]
  v_mfma_f32_16x16x32_bf16 a[176:179], v[146:149], v[86:89], a[176:179]
  s_waitcnt lgkmcnt(1)
  v_cmp_eq_u32_e64 s[20:21], 1, v234
  v_mfma_f32_16x16x32_bf16 a[180:183], v[146:149], v[90:93], a[180:183]
  s_nop 0
  v_cndmask_b32_e64 v35, 0, v235, s[20:21]
  v_cmp_eq_u32_e64 s[20:21], 2, v234
  v_mfma_f32_16x16x32_bf16 a[184:187], v[146:149], v[94:97], a[184:187]
  buffer_load_dwordx4 v[198:201], v3, s[32:35], s71 offen offset:0 sc1
  v_mfma_f32_16x16x32_bf16 a[144:147], v[150:153], v[58:61], a[144:147]
  v_cndmask_b32_e64 v36, 0, v235, s[20:21]
  v_cmp_eq_u32_e64 s[20:21], 3, v234
  v_mfma_f32_16x16x32_bf16 a[148:151], v[150:153], v[62:65], a[148:151]
  s_nop 0
  v_cndmask_b32_e64 v37, 0, v235, s[20:21]
  v_lshlrev_b32 v235, 16, v236
  v_mfma_f32_16x16x32_bf16 a[152:155], v[150:153], v[66:69], a[152:155]
  v_cmp_eq_u32_e64 s[20:21], 0, v232
  v_mfma_f32_16x16x32_bf16 a[156:159], v[150:153], v[70:73], a[156:159]
  buffer_load_dwordx4 v206, s[48:51], s92 offen offset:3072 lds
  v_mfma_f32_16x16x32_bf16 a[160:163], v[150:153], v[74:77], a[160:163]
  s_add_u32 m0, s22, 13312
  v_cndmask_b32_e64 v38, 0, v236, s[20:21]
  v_cmp_eq_u32_e64 s[20:21], 4, v232
  v_mfma_f32_16x16x32_bf16 a[164:167], v[150:153], v[78:81], a[164:167]
  s_nop 0
  v_cndmask_b32_e64 v38, v38, v235, s[20:21]
  v_mov_b32 v39, v38
  v_mfma_f32_16x16x32_bf16 a[168:171], v[150:153], v[82:85], a[168:171]
  ds_read_b128 v[106:109], v5 offset:25408
  v_mov_b32 v40, v38
  v_mfma_f32_16x16x32_bf16 a[172:175], v[150:153], v[86:89], a[172:175]
  buffer_load_dword v204, v4, s[32:35], s71 offen sc1
  v_mfma_f32_16x16x32_bf16 a[176:179], v[150:153], v[90:93], a[176:179]
  buffer_load_dwordx4 v207, s[48:51], s92 offen offset:0 lds
  v_mfma_f32_16x16x32_bf16 a[180:183], v[150:153], v[94:97], a[180:183]
  s_add_u32 m0, s22, 14336
  v_mov_b32 v41, v38
  s_lshr_b32 s61, s2, 3
  v_mfma_f32_16x16x32_bf16 a[184:187], v[150:153], v[98:101], a[184:187]
  s_lshl_b32 s61, s61, 2
  s_add_u32 s61, s61, s59
  s_mul_i32 s61, s61, 3
  v_mfma_f32_16x16x32_bf16 a[144:147], v[154:157], v[62:65], a[144:147]
  v_min_u32 v234, 2, v1
  v_add_lshl_u32 v229, v234, s61, 7
  v_mfma_f32_16x16x32_bf16 a[148:151], v[154:157], v[66:69], a[148:151]
  buffer_load_dwordx4 v208, s[48:51], s92 offen offset:0 lds
  v_mfma_f32_16x16x32_bf16 a[152:155], v[154:157], v[70:73], a[152:155]
  v_mfma_f32_16x16x32_bf16 a[156:159], v[154:157], v[74:77], a[156:159]
  v_mfma_f32_16x16x32_bf16 a[160:163], v[154:157], v[78:81], a[160:163]
  v_mfma_f32_16x16x32_bf16 a[164:167], v[154:157], v[82:85], a[164:167]
  buffer_load_dwordx4 v208, s[48:51], s92 offen offset:1024 lds
  v_mfma_f32_16x16x32_bf16 a[168:171], v[154:157], v[86:89], a[168:171]
  s_waitcnt vmcnt(26)
  v_add3_u32 v33, v162, v163, s60
  v_add3_u32 v33, v164, v165, v33
  v_mfma_f32_16x16x32_bf16 a[172:175], v[154:157], v[90:93], a[172:175]
  s_waitcnt vmcnt(24)
  v_add3_u32 v33, v166, v167, v33
  v_add3_u32 v33, v168, v169, v33
  v_mfma_f32_16x16x32_bf16 a[176:179], v[154:157], v[94:97], a[176:179]
  s_waitcnt vmcnt(22)
  v_add3_u32 v33, v170, v171, v33
  v_add3_u32 v33, v172, v173, v33
  v_mfma_f32_16x16x32_bf16 a[180:183], v[154:157], v[98:101], a[180:183]
  s_waitcnt lgkmcnt(0)
  s_waitcnt vmcnt(20)
  v_add3_u32 v33, v174, v175, v33
  v_mfma_f32_16x16x32_bf16 a[184:187], v[154:157], v[102:105], a[184:187]
  buffer_load_dwordx4 v208, s[48:51], s92 offen offset:2048 lds
  v_mfma_f32_16x16x32_bf16 a[144:147], v[158:161], v[66:69], a[144:147]
  v_add3_u32 v33, v176, v177, v33
  v_mfma_f32_16x16x32_bf16 a[148:151], v[158:161], v[70:73], a[148:151]
  s_waitcnt vmcnt(20)
  v_add3_u32 v33, v178, v179, v33
  v_add3_u32 v33, v180, v181, v33
  v_mfma_f32_16x16x32_bf16 a[152:155], v[158:161], v[74:77], a[152:155]
  buffer_load_dwordx4 v208, s[48:51], s92 offen offset:3072 lds
  v_mfma_f32_16x16x32_bf16 a[156:159], v[158:161], v[78:81], a[156:159]
  ds_read_b128 v[110:113], v5 offset:25472
  v_mfma_f32_16x16x32_bf16 a[160:163], v[158:161], v[82:85], a[160:163]
  s_waitcnt vmcnt(19)
  v_cmp_ne_u32 vcc, v33, v203
  s_nop 0
  s_cbranch_vccnz L_r1_4
L_r1_4_back:
  v_mfma_f32_16x16x32_bf16 a[164:167], v[158:161], v[86:89], a[164:167]
  ds_read_b128 v[114:117], v5 offset:25536
  v_mfma_f32_16x16x32_bf16 a[168:171], v[158:161], v[90:93], a[168:171]
  v_mfma_f32_16x16x32_bf16 a[172:175], v[158:161], v[94:97], a[172:175]
  v_mfma_f32_16x16x32_bf16 a[176:179], v[158:161], v[98:101], a[176:179]
  s_add_u32 s71, s70, 129024
  v_mfma_f32_16x16x32_bf16 a[180:183], v[158:161], v[102:105], a[180:183]
  ds_read_b128 v[118:121], v5 offset:25600
  v_mfma_f32_16x16x32_bf16 a[184:187], v[158:161], v[106:109], a[184:187]
  v_mfma_f32_16x16x32_bf16 a[144:147], v[162:165], v[70:73], a[144:147]
  buffer_load_dwordx4 v[142:145], v2, s[32:35], s71 offen offset:0 sc1
  v_mfma_f32_16x16x32_bf16 a[148:151], v[162:165], v[74:77], a[148:151]
  v_mfma_f32_16x16x32_bf16 a[152:155], v[162:165], v[78:81], a[152:155]
  ds_read_b128 v[122:125], v5 offset:25664
  v_mfma_f32_16x16x32_bf16 a[156:159], v[162:165], v[82:85], a[156:159]
  v_mfma_f32_16x16x32_bf16 a[160:163], v[162:165], v[86:89], a[160:163]
  buffer_load_dwordx4 v[146:149], v2, s[32:35], s71 offen offset:1024 sc1
  v_mfma_f32_16x16x32_bf16 a[164:167], v[162:165], v[90:93], a[164:167]
  v_mfma_f32_16x16x32_bf16 a[168:171], v[162:165], v[94:97], a[168:171]
  ds_read_b128 v[126:129], v5 offset:25728
  v_mfma_f32_16x16x32_bf16 a[172:175], v[162:165], v[98:101], a[172:175]
  v_mfma_f32_16x16x32_bf16 a[176:179], v[162:165], v[102:105], a[176:179]
  buffer_load_dwordx4 v[150:153], v2, s[32:35], s71 offen offset:2048 sc1
  v_mfma_f32_16x16x32_bf16 a[180:183], v[162:165], v[106:109], a[180:183]
  s_waitcnt lgkmcnt(2)
  v_mfma_f32_16x16x32_bf16 a[184:187], v[162:165], v[110:113], a[184:187]
  ds_read_b128 v[130:133], v5 offset:25792
  v_mfma_f32_16x16x32_bf16 a[144:147], v[166:169], v[74:77], a[144:147]
  v_mfma_f32_16x16x32_bf16 a[148:151], v[166:169], v[78:81], a[148:151]
  buffer_load_dwordx4 v[154:157], v2, s[32:35], s71 offen offset:3072 sc1
  v_mfma_f32_16x16x32_bf16 a[152:155], v[166:169], v[82:85], a[152:155]
  v_mfma_f32_16x16x32_bf16 a[156:159], v[166:169], v[86:89], a[156:159]
  ds_read_b128 v[134:137], v5 offset:25856
  v_mfma_f32_16x16x32_bf16 a[160:163], v[166:169], v[90:93], a[160:163]
  v_mfma_f32_16x16x32_bf16 a[164:167], v[166:169], v[94:97], a[164:167]
  buffer_load_dwordx4 v[158:161], v3, s[32:35], s71 offen offset:0 sc1
  v_mfma_f32_16x16x32_bf16 a[168:171], v[166:169], v[98:101], a[168:171]
  v_mfma_f32_16x16x32_bf16 a[172:175], v[166:169], v[102:105], a[172:175]
  ds_read_b128 v[138:141], v5 offset:25920
  v_mfma_f32_16x16x32_bf16 a[176:179], v[166:169], v[106:109], a[176:179]
  v_mfma_f32_16x16x32_bf16 a[180:183], v[166:169], v[110:113], a[180:183]
  buffer_load_dword v202, v4, s[32:35], s71 offen sc1
  v_mfma_f32_16x16x32_bf16 a[184:187], v[166:169], v[114:117], a[184:187]
  s_add_u32 m0, s22, 18432
  s_mov_b32 s92, 165888
  v_mfma_f32_16x16x32_bf16 a[144:147], v[170:173], v[78:81], a[144:147]
  ds_read_b128 v[46:49], v5 offset:25984
  v_mfma_f32_16x16x32_bf16 a[148:151], v[170:173], v[82:85], a[148:151]
  buffer_load_dwordx4 v206, s[48:51], s92 offen offset:0 lds
  v_mfma_f32_16x16x32_bf16 a[152:155], v[170:173], v[86:89], a[152:155]
  v_mfma_f32_16x16x32_bf16 a[156:159], v[170:173], v[90:93], a[156:159]
  v_mfma_f32_16x16x32_bf16 a[160:163], v[170:173], v[94:97], a[160:163]
  ds_read_b128 v[50:53], v5 offset:26048
  v_mfma_f32_16x16x32_bf16 a[164:167], v[170:173], v[98:101], a[164:167]
  buffer_load_dwordx4 v206, s[48:51], s92 offen offset:1024 lds
  v_mfma_f32_16x16x32_bf16 a[168:171], v[170:173], v[102:105], a[168:171]
  v_mfma_f32_16x16x32_bf16 a[172:175], v[170:173], v[106:109], a[172:175]
  v_mfma_f32_16x16x32_bf16 a[176:179], v[170:173], v[110:113], a[176:179]
  ds_read_b128 v[54:57], v5 offset:26112
  v_mfma_f32_16x16x32_bf16 a[180:183], v[170:173], v[114:117], a[180:183]
  buffer_load_dwordx4 v206, s[48:51], s92 offen offset:2048 lds
  v_mfma_f32_16x16x32_bf16 a[184:187], v[170:173], v[118:121], a[184:187]
  v_mfma_f32_16x16x32_bf16 a[144:147], v[174:177], v[82:85], a[144:147]
  v_mfma_f32_16x16x32_bf16 a[148:151], v[174:177], v[86:89], a[148:151]
  v_mfma_f32_16x16x32_bf16 a[152:155], v[174:177], v[90:93], a[152:155]
  buffer_load_dwordx4 v206, s[48:51], s92 offen offset:3072 lds
  v_mfma_f32_16x16x32_bf16 a[156:159], v[174:177], v[94:97], a[156:159]
  s_waitcnt vmcnt(10)
  s_barrier
  v_mfma_f32_16x16x32_bf16 a[160:163], v[174:177], v[98:101], a[160:163]
  s_add_u32 m0, s22, 22528
  ds_read_b64_tr_b16 a[0:1], v213 offset:256
  v_mfma_f32_16x16x32_bf16 a[164:167], v[174:177], v[102:105], a[164:167]
  ds_read_b64_tr_b16 a[2:3], v213 offset:2560
  v_add3_u32 v33, v182, v183, s60
  v_mfma_f32_16x16x32_bf16 a[168:171], v[174:177], v[106:109], a[168:171]
  buffer_load_dwordx4 v207, s[48:51], s92 offen offset:0 lds
  v_mfma_f32_16x16x32_bf16 a[172:175], v[174:177], v[110:113], a[172:175]
  ds_read_b64_tr_b16 a[16:17], v210 offset:0
  v_add3_u32 v33, v184, v185, v33
  v_mfma_f32_16x16x32_bf16 a[176:179], v[174:177], v[114:117], a[176:179]
  s_add_u32 m0, s22, 23552
  ds_read_b64_tr_b16 a[18:19], v210 offset:2304
  v_mfma_f32_16x16x32_bf16 a[180:183], v[174:177], v[118:121], a[180:183]
  s_waitcnt lgkmcnt(4)
  ds_read_b64_tr_b16 a[20:21], v210 offset:32
  v_mfma_f32_16x16x32_bf16 a[184:187], v[174:177], v[122:125], a[184:187]
  buffer_load_dwordx4 v208, s[48:51], s92 offen offset:0 lds
  v_mfma_f32_16x16x32_bf16 a[144:147], v[178:181], v[86:89], a[144:147]
  ds_read_b64_tr_b16 a[22:23], v210 offset:2336
  v_add3_u32 v33, v186, v187, v33
  v_mfma_f32_16x16x32_bf16 a[148:151], v[178:181], v[90:93], a[148:151]
  ds_read_b64_tr_b16 a[48:49], v210 offset:36864
  v_add3_u32 v33, v188, v189, v33
  v_mfma_f32_16x16x32_bf16 a[152:155], v[178:181], v[94:97], a[152:155]
  buffer_load_dword v230, v229, s[36:39], 0 offen
  v_mfma_f32_16x16x32_bf16 a[156:159], v[178:181], v[98:101], a[156:159]
  buffer_load_dword v231, v229, s[40:43], 0 offen
  v_mfma_f32_16x16x32_bf16 a[160:163], v[178:181], v[102:105], a[160:163]
  buffer_load_dwordx4 v208, s[48:51], s92 offen offset:1024 lds
  v_mfma_f32_16x16x32_bf16 a[164:167], v[178:181], v[106:109], a[164:167]
L_pad2:
  s_cbranch_execz L_padr
  ds_read_b64_tr_b16 a[50:51], v210 offset:39168
  v_add3_u32 v33, v190, v191, v33
  v_mfma_f32_16x16x32_bf16 a[168:171], v[178:181], v[110:113], a[168:171]
  ds_read_b64_tr_b16 a[52:53], v210 offset:36896
  v_add3_u32 v33, v192, v193, v33
  v_mfma_f32_16x16x32_bf16 a[172:175], v[178:181], v[114:117], a[172:175]
  v_add3_u32 v33, v194, v195, v33
  v_add3_u32 v33, v196, v197, v33
  v_mfma_f32_16x16x32_bf16 a[176:179], v[178:181], v[118:121], a[176:179]
  buffer_load_dwordx4 v208, s[48:51], s92 offen offset:2048 lds
  v_mfma_f32_16x16x32_bf16 a[180:183], v[178:181], v[122:125], a[180:183]
  ds_read_b64_tr_b16 a[54:55], v210 offset:39200
  v_add3_u32 v33, v198, v199, v33
  v_mfma_f32_16x16x32_bf16 a[184:187], v[178:181], v[126:129], a[184:187]
  v_add3_u32 v33, v200, v201, v33
  v_cmp_ne_u32 vcc, v33, v204
  s_nop 0
  s_cbranch_vccnz L_r1_5
L_r1_5_back:
  ds_read_b64_tr_b16 a[80:81], v211 offset:24576
  v_mfma_f32_16x16x32_bf16 a[144:147], v[182:185], v[90:93], a[144:147]
  ds_read_b64_tr_b16 a[82:83], v211 offset:26880
  v_mfma_f32_16x16x32_bf16 a[148:151], v[182:185], v[94:97], a[148:151]
  ds_read_b64_tr_b16 a[84:85], v211 offset:24608
  v_mfma_f32_16x16x32_bf16 a[152:155], v[182:185], v[98:101], a[152:155]
  buffer_load_dwordx4 v208, s[48:51], s92 offen offset:3072 lds
  v_mfma_f32_16x16x32_bf16 a[156:159], v[182:185], v[102:105], a[156:159]
  ds_read_b64_tr_b16 a[86:87], v211 offset:26912
  v_mfma_f32_16x16x32_bf16 a[160:163], v[182:185], v[106:109], a[160:163]
  s_add_u32 m0, s22, 27648
  s_mov_b32 s92, 248832
  v_mfma_f32_16x16x32_bf16 a[164:167], v[182:185], v[110:113], a[164:167]
  ds_read_b64_tr_b16 a[112:113], v212 offset:12288
  v_mfma_f32_16x16x32_bf16 a[168:171], v[182:185], v[114:117], a[168:171]
  ds_read_b64_tr_b16 a[114:115], v212 offset:14592
  v_mfma_f32_16x16x32_bf16 a[172:175], v[182:185], v[118:121], a[172:175]
  ds_read_b64_tr_b16 a[116:117], v212 offset:12320
  v_mfma_f32_16x16x32_bf16 a[176:179], v[182:185], v[122:125], a[176:179]
  buffer_load_dwordx4 v206, s[48:51], s92 offen offset:0 lds
  v_mfma_f32_16x16x32_bf16 a[180:183], v[182:185], v[126:129], a[180:183]
  ds_read_b64_tr_b16 a[118:119], v212 offset:14624
  v_mfma_f32_16x16x32_bf16 a[184:187], v[182:185], v[130:133], a[184:187]
  ds_read_b64_tr_b16 a[4:5], v213 offset:9472
  v_mfma_f32_16x16x32_bf16 a[144:147], v[186:189], v[94:97], a[144:147]
  ds_read_b64_tr_b16 a[6:7], v213 offset:11776
  v_mfma_f32_16x16x32_bf16 a[148:151], v[186:189], v[98:101], a[148:151]
  buffer_load_dwordx4 v206, s[48:51], s92 offen offset:1024 lds
  v_mfma_f32_16x16x32_bf16 a[152:155], v[186:189], v[102:105], a[152:155]
  ds_read_b64_tr_b16 a[24:25], v210 offset:9216
  v_mfma_f32_16x16x32_bf16 a[156:159], v[186:189], v[106:109], a[156:159]
  ds_read_b64_tr_b16 a[26:27], v210 offset:11520
  v_mfma_f32_16x16x32_bf16 a[160:163], v[186:189], v[110:113], a[160:163]
  ds_read_b64_tr_b16 a[28:29], v210 offset:9248
  v_mfma_f32_16x16x32_bf16 a[164:167], v[186:189], v[114:117], a[164:167]
  buffer_load_dwordx4 v206, s[48:51], s92 offen offset:2048 lds
  v_mfma_f32_16x16x32_bf16 a[168:171], v[186:189], v[118:121], a[168:171]
  ds_read_b64_tr_b16 a[30:31], v210 offset:11552
  v_mfma_f32_16x16x32_bf16 a[172:175], v[186:189], v[122:125], a[172:175]
  ds_read_b64_tr_b16 a[56:57], v210 offset:46080
  v_mfma_f32_16x16x32_bf16 a[176:179], v[186:189], v[126:129], a[176:179]
  ds_read_b64_tr_b16 a[58:59], v210 offset:48384
  v_mfma_f32_16x16x32_bf16 a[180:183], v[186:189], v[130:133], a[180:183]
  buffer_load_dwordx4 v206, s[48:51], s92 offen offset:3072 lds
  v_mfma_f32_16x16x32_bf16 a[184:187], v[186:189], v[134:137], a[184:187]
  ds_read_b64_tr_b16 a[60:61], v210 offset:46112
  s_add_u32 m0, s22, 31744
  v_mfma_f32_16x16x32_bf16 a[144:147], v[190:193], v[98:101], a[144:147]
  ds_read_b64_tr_b16 a[62:63], v210 offset:48416
  v_mfma_f32_16x16x32_bf16 a[148:151], v[190:193], v[102:105], a[148:151]
  ds_read_b64_tr_b16 a[88:89], v211 offset:33792
  v_mfma_f32_16x16x32_bf16 a[152:155], v[190:193], v[106:109], a[152:155]
  ds_read_b64_tr_b16 a[90:91], v211 offset:36096
  v_mfma_f32_16x16x32_bf16 a[156:159], v[190:193], v[110:113], a[156:159]
  buffer_load_dwordx4 v207, s[48:51], s92 offen offset:0 lds
  v_mfma_f32_16x16x32_bf16 a[160:163], v[190:193], v[114:117], a[160:163]
  ds_read_b64_tr_b16 a[92:93], v211 offset:33824
  s_add_u32 m0, s22, 32768
  v_mfma_f32_16x16x32_bf16 a[164:167], v[190:193], v[118:121], a[164:167]
  s_lshl_b32 s66, s54, 7
  s_add_u32 s66, s66, 97792
  v_mfma_f32_16x16x32_bf16 a[168:171], v[190:193], v[122:125], a[168:171]
  ds_read_b64_tr_b16 a[94:95], v211 offset:36128
  v_mfma_f32_16x16x32_bf16 a[172:175], v[190:193], v[126:129], a[172:175]
  ds_read_b64_tr_b16 a[120:121], v212 offset:21504
  v_mfma_f32_16x16x32_bf16 a[176:179], v[190:193], v[130:133], a[176:179]
  ds_read_b64_tr_b16 a[122:123], v212 offset:23808
  v_mfma_f32_16x16x32_bf16 a[180:183], v[190:193], v[134:137], a[180:183]
  buffer_load_dwordx4 v208, s[48:51], s92 offen offset:0 lds
  v_mfma_f32_16x16x32_bf16 a[184:187], v[190:193], v[138:141], a[184:187]
  ds_read_b64_tr_b16 a[124:125], v212 offset:21536
  v_mfma_f32_16x16x32_bf16 a[144:147], v[194:197], v[102:105], a[144:147]
  ds_read_b64_tr_b16 a[126:127], v212 offset:23840
  v_mfma_f32_16x16x32_bf16 a[148:151], v[194:197], v[106:109], a[148:151]
  buffer_load_dword v203, off, s[32:35], s66 sc1
  v_mfma_f32_16x16x32_bf16 a[152:155], v[194:197], v[110:113], a[152:155]
  buffer_load_dwordx4 v208, s[48:51], s92 offen offset:1024 lds
  v_mfma_f32_16x16x32_bf16 a[156:159], v[194:197], v[114:117], a[156:159]
  ds_read_b128 v[58:61], v7 offset:0
  v_mfma_f32_16x16x32_bf16 a[160:163], v[194:197], v[118:121], a[160:163]
  v_mfma_f32_16x16x32_bf16 a[164:167], v[194:197], v[122:125], a[164:167]
  s_waitcnt vmcnt(24)
  v_add3_u32 v33, v142, v143, s60
  v_add3_u32 v33, v144, v145, v33
  v_mfma_f32_16x16x32_bf16 a[168:171], v[194:197], v[126:129], a[168:171]
  buffer_load_dwordx4 v208, s[48:51], s92 offen offset:2048 lds
  v_mfma_f32_16x16x32_bf16 a[172:175], v[194:197], v[130:133], a[172:175]
  s_waitcnt vmcnt(24)
  v_add3_u32 v33, v146, v147, v33
  v_add3_u32 v33, v148, v149, v33
  v_mfma_f32_16x16x32_bf16 a[176:179], v[194:197], v[134:137], a[176:179]
  s_waitcnt vmcnt(23)
  v_add3_u32 v33, v150, v151, v33
  v_add3_u32 v33, v152, v153, v33
  v_mfma_f32_16x16x32_bf16 a[180:183], v[194:197], v[138:141], a[180:183]
  s_waitcnt vmcnt(22)
  v_add3_u32 v33, v154, v155, v33
  v_add3_u32 v33, v156, v157, v33
  v_mfma_f32_16x16x32_bf16 a[184:187], v[194:197], v[46:49], a[184:187]
  buffer_load_dwordx4 v208, s[48:51], s92 offen offset:3072 lds
  v_mfma_f32_16x16x32_bf16 a[144:147], v[198:201], v[106:109], a[144:147]
  s_waitcnt vmcnt(10)
  s_waitcnt lgkmcnt(1)
  s_barrier
  v_mfma_f32_16x16x32_bf16 a[148:151], v[198:201], v[110:113], a[148:151]
  ds_read_b64_tr_b16 a[8:9], v213 offset:18688
  v_add3_u32 v33, v158, v159, v33
  v_mfma_f32_16x16x32_bf16 a[152:155], v[198:201], v[114:117], a[152:155]
  ds_read_b64_tr_b16 a[10:11], v213 offset:20992
  v_add3_u32 v33, v160, v161, v33
  v_mfma_f32_16x16x32_bf16 a[156:159], v[198:201], v[118:121], a[156:159]
  buffer_store_dwordx4 v[42:45], v16, s[32:35], s93 offen offset:0 sc1
  v_mfma_f32_16x16x32_bf16 a[160:163], v[198:201], v[122:125], a[160:163]
  ds_read_b64_tr_b16 a[32:33], v210 offset:18432
  v_mfma_f32_16x16x32_bf16 a[164:167], v[198:201], v[126:129], a[164:167]
  ds_read_b64_tr_b16 a[34:35], v210 offset:20736
  v_mfma_f32_16x16x32_bf16 a[168:171], v[198:201], v[130:133], a[168:171]
  v_cmp_ne_u32 vcc, v33, v202
  s_nop 0
  s_cbranch_vccnz L_r1_6
L_r1_6_back:
  v_mfma_f32_16x16x32_bf16 a[172:175], v[198:201], v[134:137], a[172:175]
  ds_read_b64_tr_b16 a[36:37], v210 offset:18464
  v_mfma_f32_16x16x32_bf16 a[176:179], v[198:201], v[138:141], a[176:179]
  ds_read_b128 v[62:65], v7 offset:64
  v_mfma_f32_16x16x32_bf16 a[180:183], v[198:201], v[46:49], a[180:183]
  buffer_store_dwordx4 v[42:45], v16, s[32:35], s93 offen offset:1024 sc1
  v_mfma_f32_16x16x32_bf16 a[184:187], v[198:201], v[50:53], a[184:187]
  ds_read_b64_tr_b16 a[38:39], v210 offset:20768
  v_mfma_f32_16x16x32_bf16 a[144:147], v[142:145], v[110:113], a[144:147]
  ds_read_b128 v[66:69], v7 offset:128
  v_mfma_f32_16x16x32_bf16 a[148:151], v[142:145], v[114:117], a[148:151]
  v_mfma_f32_16x16x32_bf16 a[152:155], v[142:145], v[118:121], a[152:155]
  ds_read_b64_tr_b16 a[64:65], v211 offset:6144
  v_mfma_f32_16x16x32_bf16 a[156:159], v[142:145], v[122:125], a[156:159]
  ds_read_b128 v[70:73], v7 offset:192
  v_mfma_f32_16x16x32_bf16 a[160:163], v[142:145], v[126:129], a[160:163]
  ds_read_b64_tr_b16 a[66:67], v211 offset:8448
  v_mfma_f32_16x16x32_bf16 a[164:167], v[142:145], v[130:133], a[164:167]
  ds_read_b64_tr_b16 a[68:69], v211 offset:6176
  v_mfma_f32_16x16x32_bf16 a[168:171], v[142:145], v[134:137], a[168:171]
  buffer_store_dwordx4 v[42:45], v16, s[32:35], s93 offen offset:2048 sc1
  v_mfma_f32_16x16x32_bf16 a[172:175], v[142:145], v[138:141], a[172:175]
  ds_read_b64_tr_b16 a[70:71], v211 offset:8480
  v_mfma_f32_16x16x32_bf16 a[176:179], v[142:145], v[46:49], a[176:179]
  ds_read_b64_tr_b16 a[96:97], v211 offset:43008
  v_mfma_f32_16x16x32_bf16 a[180:183], v[142:145], v[50:53], a[180:183]
  ds_read_b128 v[74:77], v7 offset:256
  ds_read_b64_tr_b16 a[98:99], v211 offset:45312
  v_mfma_f32_16x16x32_bf16 a[184:187], v[142:145], v[54:57], a[184:187]
  s_waitcnt lgkmcnt(8)
  v_mfma_f32_16x16x32_bf16 a[144:147], v[146:149], v[58:61], a[144:147]
  ds_read_b64_tr_b16 a[100:101], v211 offset:43040
  v_mfma_f32_16x16x32_bf16 a[144:147], v[150:153], v[62:65], a[144:147]
  ds_read_b64_tr_b16 a[102:103], v211 offset:45344
  v_mfma_f32_16x16x32_bf16 a[144:147], v[154:157], v[66:69], a[144:147]
  s_waitcnt lgkmcnt(7)
  ds_read_b128 v[78:81], v7 offset:320
  v_mfma_f32_16x16x32_bf16 a[144:147], v[158:161], v[70:73], a[144:147]
  ds_read_b64_tr_b16 a[128:129], v212 offset:30720
  v_mfma_f32_16x16x32_bf16 a[148:151], v[146:149], v[62:65], a[148:151]
  ds_read_b64_tr_b16 a[130:131], v212 offset:33024
  v_mfma_f32_16x16x32_bf16 a[148:151], v[150:153], v[66:69], a[148:151]
  buffer_store_dwordx4 v[42:45], v16, s[32:35], s93 offen offset:3072 sc1
  v_mfma_f32_16x16x32_bf16 a[148:151], v[154:157], v[70:73], a[148:151]
  s_waitcnt lgkmcnt(6)
  ds_read_b128 v[82:85], v7 offset:384
  ds_read_b64_tr_b16 a[132:133], v212 offset:30752
  v_mfma_f32_16x16x32_bf16 a[148:151], v[158:161], v[74:77], a[148:151]
  ds_read_b64_tr_b16 a[134:135], v212 offset:33056
  v_mfma_f32_16x16x32_bf16 a[152:155], v[146:149], v[66:69], a[152:155]
  v_mfma_f32_16x16x32_bf16 a[152:155], v[150:153], v[70:73], a[152:155]
  ds_write_b128 v8, a[144:147] offset:0
  v_mfma_f32_16x16x32_bf16 a[152:155], v[154:157], v[74:77], a[152:155]
  s_waitcnt lgkmcnt(6)
  ds_read_b128 v[86:89], v7 offset:448
  v_mfma_f32_16x16x32_bf16 a[152:155], v[158:161], v[78:81], a[152:155]
  buffer_store_dwordx2 v[42:43], v17, s[32:35], s19 offen sc1
  v_mfma_f32_16x16x32_bf16 a[156:159], v[146:149], v[70:73], a[156:159]
  v_mfma_f32_16x16x32_bf16 a[156:159], v[150:153], v[74:77], a[156:159]
  s_mul_i32 s65, s59, 9216
  s_add_u32 m0, s22, 11264
  v_mfma_f32_16x16x32_bf16 a[156:159], v[154:157], v[78:81], a[156:159]
  s_waitcnt lgkmcnt(4)
  ds_read_b128 v[90:93], v7 offset:512
  ds_write_b128 v8, a[148:151] offset:1024
  v_mfma_f32_16x16x32_bf16 a[156:159], v[158:161], v[82:85], a[156:159]
  buffer_load_dwordx4 v2, s[36:39], s65 offen offset:0 lds
  v_mfma_f32_16x16x32_bf16 a[160:163], v[146:149], v[74:77], a[160:163]
  v_mfma_f32_16x16x32_bf16 a[160:163], v[150:153], v[78:81], a[160:163]
  v_mfma_f32_16x16x32_bf16 a[160:163], v[154:157], v[82:85], a[160:163]
  s_waitcnt lgkmcnt(2)
  ds_read_b128 v[94:97], v7 offset:576
  ds_write_b128 v8, a[152:155] offset:2048
  v_mfma_f32_16x16x32_bf16 a[160:163], v[158:161], v[86:89], a[160:163]
  buffer_load_dwordx4 v2, s[36:39], s65 offen offset:1024 lds
  v_mfma_f32_16x16x32_bf16 a[164:167], v[146:149], v[78:81], a[164:167]
  v_mfma_f32_16x16x32_bf16 a[164:167], v[150:153], v[82:85], a[164:167]
  v_mfma_f32_16x16x32_bf16 a[164:167], v[154:157], v[86:89], a[164:167]
  s_waitcnt lgkmcnt(2)
  ds_read_b128 v[98:101], v7 offset:640
  ds_write_b128 v8, a[156:159] offset:3072
  v_mfma_f32_16x16x32_bf16 a[164:167], v[158:161], v[90:93], a[164:167]
  buffer_load_dwordx4 v2, s[36:39], s65 offen offset:2048 lds
  v_mfma_f32_16x16x32_bf16 a[168:171], v[146:149], v[82:85], a[168:171]
  v_mfma_f32_16x16x32_bf16 a[168:171], v[150:153], v[86:89], a[168:171]
  v_mfma_f32_16x16x32_bf16 a[168:171], v[154:157], v[90:93], a[168:171]
  s_waitcnt lgkmcnt(2)
  ds_read_b128 v[102:105], v7 offset:704
  ds_write_b128 v8, a[160:163] offset:4096
  v_mfma_f32_16x16x32_bf16 a[168:171], v[158:161], v[94:97], a[168:171]
  buffer_load_dwordx4 v2, s[36:39], s65 offen offset:3072 lds
  v_mfma_f32_16x16x32_bf16 a[172:175], v[146:149], v[86:89], a[172:175]
  v_mfma_f32_16x16x32_bf16 a[172:175], v[150:153], v[90:93], a[172:175]
  s_add_u32 s65, s65, 4096
  s_add_u32 m0, s22, 15360
  v_mfma_f32_16x16x32_bf16 a[172:175], v[154:157], v[94:97], a[172:175]
  s_waitcnt lgkmcnt(2)
  ds_read_b128 v[106:109], v7 offset:768
  ds_write_b128 v8, a[164:167] offset:5120
  v_mfma_f32_16x16x32_bf16 a[172:175], v[158:161], v[98:101], a[172:175]
  buffer_load_dwordx4 v2, s[36:39], s65 offen offset:0 lds
  v_mfma_f32_16x16x32_bf16 a[176:179], v[146:149], v[90:93], a[176:179]
  v_mfma_f32_16x16x32_bf16 a[176:179], v[150:153], v[94:97], a[176:179]
  v_mfma_f32_16x16x32_bf16 a[176:179], v[154:157], v[98:101], a[176:179]
  s_waitcnt lgkmcnt(2)
  ds_read_b128 v[110:113], v7 offset:832
  ds_write_b128 v8, a[168:171] offset:6144
  v_mfma_f32_16x16x32_bf16 a[176:179], v[158:161], v[102:105], a[176:179]
  buffer_load_dwordx4 v2, s[36:39], s65 offen offset:1024 lds
  v_mfma_f32_16x16x32_bf16 a[180:183], v[146:149], v[94:97], a[180:183]
  v_mfma_f32_16x16x32_bf16 a[180:183], v[150:153], v[98:101], a[180:183]
  v_mfma_f32_16x16x32_bf16 a[180:183], v[154:157], v[102:105], a[180:183]
  s_waitcnt lgkmcnt(2)
  ds_write_b128 v8, a[172:175] offset:7168
  v_mfma_f32_16x16x32_bf16 a[180:183], v[158:161], v[106:109], a[180:183]
  buffer_load_dwordx4 v2, s[36:39], s65 offen offset:2048 lds
  v_mfma_f32_16x16x32_bf16 a[184:187], v[146:149], v[98:101], a[184:187]
  ds_write_b128 v8, a[176:179] offset:8192
  v_mfma_f32_16x16x32_bf16 a[184:187], v[150:153], v[102:105], a[184:187]
  v_mfma_f32_16x16x32_bf16 a[184:187], v[154:157], v[106:109], a[184:187]
  s_waitcnt lgkmcnt(2)
  v_mfma_f32_16x16x32_bf16 a[184:187], v[158:161], v[110:113], a[184:187]
  s_nop 0
  ds_write_b128 v8, a[180:183] offset:9216
  s_nop 5
  ds_write_b128 v8, a[184:187] offset:10240
  s_waitcnt vmcnt(12)
  s_waitcnt lgkmcnt(0)
  s_barrier
  ds_read_b128 v[46:49], v9 offset:0
  ds_read_b128 v[50:53], v9 offset:36864
  ds_read_b128 v[54:57], v12 offset:0
  ds_read_b128 v[58:61], v12 offset:36864
  ds_read_b128 v[62:65], v9 offset:1024
  ds_read_b128 v[66:69], v9 offset:37888
  ds_read_b128 v[70:73], v12 offset:1024
  ds_read_b128 v[74:77], v12 offset:37888
  ds_read_b128 v[78:81], v9 offset:2048
  ds_read_b128 v[82:85], v9 offset:38912
  ds_read_b128 v[86:89], v12 offset:2048
  ds_read_b128 v[90:93], v12 offset:38912
  ds_read_b64_tr_b16 a[12:13], v213 offset:27904
  ds_read_b64_tr_b16 a[14:15], v213 offset:30208
  ds_read_b64_tr_b16 a[40:41], v210 offset:27648
  ds_read_b64_tr_b16 a[42:43], v210 offset:29952
  ds_read_b64_tr_b16 a[44:45], v210 offset:27680
  ds_read_b64_tr_b16 a[46:47], v210 offset:29984
  ds_read_b64_tr_b16 a[72:73], v211 offset:15360
  ds_read_b64_tr_b16 a[74:75], v211 offset:17664
  buffer_load_dwordx4 v2, s[36:39], s65 offen offset:3072 lds
  s_add_u32 s65, s65, 4096
  s_add_u32 m0, s22, 19456
  s_nop 0
  buffer_load_dwordx4 v2, s[36:39], s65 offen offset:0 lds
  s_lshl_b32 s65, s59, 10
  s_add_u32 m0, s65, 20480
  s_add_u32 s65, s65, 36864
  buffer_load_dwordx4 v2, s[36:39], s65 offen offset:0 lds
  s_waitcnt lgkmcnt(15)
  v_pk_add_f32 v[46:47], v[46:47], v[50:51]
  s_mov_b32 m0, 24576
  s_mov_b32 s65, 40960
  buffer_load_dwordx4 v2, s[36:39], s65 offen offset:0 lds
  v_pk_add_f32 v[54:55], v[54:55], v[58:59]
  v_pk_add_f32 v[48:49], v[48:49], v[52:53]
  v_pk_add_f32 v[56:57], v[56:57], v[60:61]
  v_pk_add_f32 v[46:47], v[46:47], v[54:55]
  v_pk_add_f32 v[48:49], v[48:49], v[56:57]
  s_waitcnt lgkmcnt(14)
  v_pk_add_f32 v[62:63], v[62:63], v[66:67]
  s_waitcnt lgkmcnt(12)
  v_pk_add_f32 v[70:71], v[70:71], v[74:75]
  v_pk_add_f32 v[64:65], v[64:65], v[68:69]
  v_pk_add_f32 v[72:73], v[72:73], v[76:77]
  v_pk_add_f32 v[62:63], v[62:63], v[70:71]
  v_pk_add_f32 v[64:65], v[64:65], v[72:73]
  s_waitcnt lgkmcnt(10)
  v_pk_add_f32 v[78:79], v[78:79], v[82:83]
  s_waitcnt lgkmcnt(8)
  v_pk_add_f32 v[86:87], v[86:87], v[90:91]
  v_pk_add_f32 v[80:81], v[80:81], v[84:85]
  v_pk_add_f32 v[88:89], v[88:89], v[92:93]
  v_pk_add_f32 v[78:79], v[78:79], v[86:87]
  v_pk_add_f32 v[80:81], v[80:81], v[88:89]
  v_pk_mul_f32 v[50:51], v[46:47], v[46:47]
  v_pk_mul_f32 v[52:53], v[48:49], v[48:49]
  v_pk_mul_f32 v[66:67], v[62:63], v[62:63]
  v_pk_mul_f32 v[68:69], v[64:65], v[64:65]
  v_pk_mul_f32 v[82:83], v[78:79], v[78:79]
  v_pk_mul_f32 v[84:85], v[80:81], v[80:81]
  v_pk_fma_f32 v[50:51], v[50:51], s[98:99], s[98:99] op_sel:[0,0,1] op_sel_hi:[1,0,1]
  v_pk_fma_f32 v[52:53], v[52:53], s[98:99], s[98:99] op_sel:[0,0,1] op_sel_hi:[1,0,1]
  v_pk_fma_f32 v[66:67], v[66:67], s[98:99], s[98:99] op_sel:[0,0,1] op_sel_hi:[1,0,1]
  v_pk_fma_f32 v[68:69], v[68:69], s[98:99], s[98:99] op_sel:[0,0,1] op_sel_hi:[1,0,1]
  v_pk_fma_f32 v[82:83], v[82:83], s[98:99], s[98:99] op_sel:[0,0,1] op_sel_hi:[1,0,1]
  v_pk_fma_f32 v[84:85], v[84:85], s[98:99], s[98:99] op_sel:[0,0,1] op_sel_hi:[1,0,1]
  v_pk_mul_f32 v[50:51], v[50:51], v[46:47]
  v_pk_mul_f32 v[52:53], v[52:53], v[48:49]
  v_pk_mul_f32 v[66:67], v[66:67], v[62:63]
  v_pk_mul_f32 v[68:69], v[68:69], v[64:65]
  v_pk_mul_f32 v[82:83], v[82:83], v[78:79]
  v_pk_mul_f32 v[84:85], v[84:85], v[80:81]
  v_exp_f32 v50, v50
  v_exp_f32 v51, v51
  v_exp_f32 v52, v52
  v_exp_f32 v53, v53
  v_exp_f32 v66, v66
  v_exp_f32 v67, v67
  v_exp_f32 v68, v68
  v_exp_f32 v69, v69
  v_exp_f32 v82, v82
  v_exp_f32 v83, v83
  v_exp_f32 v84, v84
  v_exp_f32 v85, v85
  v_pk_add_f32 v[50:51], v[50:51], 1.0 op_sel_hi:[1,0]
  v_pk_add_f32 v[52:53], v[52:53], 1.0 op_sel_hi:[1,0]
  v_pk_add_f32 v[66:67], v[66:67], 1.0 op_sel_hi:[1,0]
  v_pk_add_f32 v[68:69], v[68:69], 1.0 op_sel_hi:[1,0]
  v_pk_add_f32 v[82:83], v[82:83], 1.0 op_sel_hi:[1,0]
  v_pk_add_f32 v[84:85], v[84:85], 1.0 op_sel_hi:[1,0]
  v_rcp_f32 v50, v50
  v_rcp_f32 v51, v51
  v_rcp_f32 v52, v52
  v_rcp_f32 v53, v53
  v_rcp_f32 v66, v66
  v_rcp_f32 v67, v67
  v_rcp_f32 v68, v68
  v_rcp_f32 v69, v69
  v_rcp_f32 v82, v82
  v_rcp_f32 v83, v83
  v_rcp_f32 v84, v84
  v_rcp_f32 v85, v85
  v_pk_mul_f32 v[46:47], v[46:47], v[50:51]
  v_pk_mul_f32 v[48:49], v[48:49], v[52:53]
  v_pk_mul_f32 v[62:63], v[62:63], v[66:67]
  v_pk_mul_f32 v[64:65], v[64:65], v[68:69]
  v_pk_mul_f32 v[78:79], v[78:79], v[82:83]
  v_pk_mul_f32 v[80:81], v[80:81], v[84:85]
  v_cvt_pk_bf16_f32 v46, v46, v47
  v_cvt_pk_bf16_f32 v47, v48, v49
  v_cndmask_b32_e64 v46, 0, v46, s[74:75]
  v_cndmask_b32_e64 v47, 0, v47, s[74:75]
  ds_write_b64 v220, v[46:47]
  v_cvt_pk_bf16_f32 v62, v62, v63
  v_cvt_pk_bf16_f32 v63, v64, v65
  v_cndmask_b32_e64 v62, 0, v62, s[76:77]
  v_cndmask_b32_e64 v63, 0, v63, s[76:77]
  ds_write_b64 v221, v[62:63]
  v_cvt_pk_bf16_f32 v78, v78, v79
  v_cvt_pk_bf16_f32 v79, v80, v81
  v_cndmask_b32_e64 v78, 0, v78, s[78:79]
  v_cndmask_b32_e64 v79, 0, v79, s[78:79]
  ds_write_b64 v222, v[78:79]
  ds_read_b64_tr_b16 a[76:77], v211 offset:15392
  ds_read_b64_tr_b16 a[78:79], v211 offset:17696
  ds_read_b64_tr_b16 a[104:105], v212 offset:3072
  ds_read_b64_tr_b16 a[106:107], v212 offset:5376
  ds_read_b64_tr_b16 a[108:109], v212 offset:3104
  ds_read_b64_tr_b16 a[110:111], v212 offset:5408
  ds_read_b64_tr_b16 a[136:137], v212 offset:39936
  ds_read_b64_tr_b16 a[138:139], v212 offset:42240
  ds_read_b64_tr_b16 a[140:141], v212 offset:39968
  ds_read_b64_tr_b16 a[142:143], v212 offset:42272
  s_waitcnt vmcnt(0) lgkmcnt(0)
  s_barrier
  ds_read_b128 v[122:125], v223 offset:0
  ds_read_b128 v[126:129], v223 offset:64
  ds_read_b128 v[130:133], v223 offset:128
  ds_read_b128 v[134:137], v223 offset:192
  s_mul_i32 s61, s56, 9
  s_add_u32 s61, s61, s55
  s_lshl_b32 s61, s61, 7
  s_add_u32 s61, s61, 60416
  v_mov_b32 v33, s60
  s_cmp_eq_u32 s59, 0
  s_cbranch_scc0 L_nf
  s_mov_b32 exec_hi, 0
  buffer_store_dword v33, v4, s[32:35], s61 offen sc1
  s_mov_b64 exec, -1
L_nf:
  s_waitcnt lgkmcnt(3)
  v_mfma_f32_16x16x32_bf16 v[150:153], a[0:3], v[122:125], 0
  s_waitcnt lgkmcnt(2)
  ds_read_b128 v[138:141], v223 offset:288
  v_mfma_f32_16x16x32_bf16 v[154:157], a[0:3], v[126:129], 0
  s_mul_i32 s65, s59, 9216
  s_add_u32 m0, s22, 0
  v_mfma_f32_16x16x32_bf16 v[150:153], a[4:7], v[126:129], v[150:153]
  s_waitcnt lgkmcnt(2)
  ds_read_b128 v[142:145], v223 offset:352
  v_mfma_f32_16x16x32_bf16 v[158:161], a[0:3], v[130:133], 0
  buffer_load_dwordx4 v2, s[40:43], s65 offen offset:0 lds
  v_mfma_f32_16x16x32_bf16 v[154:157], a[4:7], v[130:133], v[154:157]
  ds_read_b128 v[146:149], v223 offset:416
  v_mfma_f32_16x16x32_bf16 v[150:153], a[8:11], v[130:133], v[150:153]
  s_waitcnt lgkmcnt(3)
  ds_read_b128 v[46:49], v11 offset:0
  v_mfma_f32_16x16x32_bf16 v[162:165], a[0:3], v[134:137], 0
  buffer_load_dwordx4 v2, s[40:43], s65 offen offset:1024 lds
  v_mfma_f32_16x16x32_bf16 v[158:161], a[4:7], v[134:137], v[158:161]
  ds_read_b128 v[50:53], v11 offset:64
  v_mfma_f32_16x16x32_bf16 v[154:157], a[8:11], v[134:137], v[154:157]
  v_mfma_f32_16x16x32_bf16 v[150:153], a[12:15], v[134:137], v[150:153]
  s_waitcnt lgkmcnt(4)
  ds_read_b128 v[54:57], v11 offset:128
  v_mfma_f32_16x16x32_bf16 v[162:165], a[4:7], v[138:141], v[162:165]
  buffer_load_dwordx4 v2, s[40:43], s65 offen offset:2048 lds
  v_mfma_f32_16x16x32_bf16 v[158:161], a[8:11], v[138:141], v[158:161]
  ds_read_b128 v[58:61], v11 offset:192
  v_mfma_f32_16x16x32_bf16 v[154:157], a[12:15], v[138:141], v[154:157]
  s_waitcnt lgkmcnt(5)
  v_mfma_f32_16x16x32_bf16 v[162:165], a[8:11], v[142:145], v[162:165]
  ds_read_b128 v[62:65], v11 offset:288
  v_mfma_f32_16x16x32_bf16 v[158:161], a[12:15], v[142:145], v[158:161]
  s_waitcnt lgkmcnt(5)
  v_mfma_f32_16x16x32_bf16 v[162:165], a[12:15], v[146:149], v[162:165]
  s_waitcnt lgkmcnt(4)
  ds_read_b128 v[66:69], v11 offset:352
  v_mfma_f32_16x16x32_bf16 v[166:169], a[16:19], v[46:49], 0
  buffer_load_dwordx4 v2, s[40:43], s65 offen offset:3072 lds
  v_mfma_f32_16x16x32_bf16 v[170:173], a[20:23], v[46:49], 0
  s_waitcnt lgkmcnt(4)
  s_add_u32 s65, s65, 4096
  s_add_u32 m0, s22, 4096
  v_mfma_f32_16x16x32_bf16 v[166:169], a[24:27], v[50:53], v[166:169]
  ds_read_b128 v[70:73], v11 offset:416
  v_mfma_f32_16x16x32_bf16 v[170:173], a[28:31], v[50:53], v[170:173]
  s_waitcnt lgkmcnt(4)
  ds_read_b128 v[74:77], v11 offset:480
  v_mfma_f32_16x16x32_bf16 v[166:169], a[32:35], v[54:57], v[166:169]
  buffer_load_dwordx4 v2, s[40:43], s65 offen offset:0 lds
  v_mfma_f32_16x16x32_bf16 v[170:173], a[36:39], v[54:57], v[170:173]
  s_waitcnt lgkmcnt(4)
  ds_read_b128 v[78:81], v11 offset:576
  v_mfma_f32_16x16x32_bf16 v[166:169], a[40:43], v[58:61], v[166:169]
  v_mfma_f32_16x16x32_bf16 v[170:173], a[44:47], v[58:61], v[170:173]
  s_waitcnt lgkmcnt(4)
  ds_read_b128 v[82:85], v11 offset:640
  v_mfma_f32_16x16x32_bf16 v[166:169], a[48:51], v[62:65], v[166:169]
  buffer_load_dwordx4 v2, s[40:43], s65 offen offset:1024 lds
  v_mfma_f32_16x16x32_bf16 v[170:173], a[52:55], v[62:65], v[170:173]
  s_waitcnt lgkmcnt(4)
  ds_read_b128 v[86:89], v11 offset:704
  v_mfma_f32_16x16x32_bf16 v[166:169], a[56:59], v[66:69], v[166:169]
  v_mfma_f32_16x16x32_bf16 v[170:173], a[60:63], v[66:69], v[170:173]
  s_waitcnt lgkmcnt(4)
  ds_read_b128 v[90:93], v11 offset:768
  v_mfma_f32_16x16x32_bf16 v[166:169], a[64:67], v[70:73], v[166:169]
  buffer_load_dwordx4 v2, s[40:43], s65 offen offset:2048 lds
  v_mfma_f32_16x16x32_bf16 v[170:173], a[68:71], v[70:73], v[170:173]
  s_waitcnt lgkmcnt(4)
  ds_read_b128 v[94:97], v11 offset:864
  v_mfma_f32_16x16x32_bf16 v[166:169], a[72:75], v[74:77], v[166:169]
  v_and_b32 v42, 48, v1
  v_lshrrev_b32 v9, 4, v1
  v_mfma_f32_16x16x32_bf16 v[170:173], a[76:79], v[74:77], v[170:173]
  s_waitcnt lgkmcnt(4)
  ds_read_b128 v[98:101], v11 offset:928
  v_mfma_f32_16x16x32_bf16 v[166:169], a[80:83], v[78:81], v[166:169]
  buffer_load_dwordx4 v2, s[40:43], s65 offen offset:3072 lds
  v_mfma_f32_16x16x32_bf16 v[170:173], a[84:87], v[78:81], v[170:173]
  s_waitcnt lgkmcnt(4)
  s_add_u32 s65, s65, 4096
  s_add_u32 m0, s22, 8192
  v_mfma_f32_16x16x32_bf16 v[166:169], a[88:91], v[82:85], v[166:169]
  ds_read_b128 v[102:105], v11 offset:992
  v_and_b32 v12, 15, v1
  v_mfma_f32_16x16x32_bf16 v[170:173], a[92:95], v[82:85], v[170:173]
  s_waitcnt lgkmcnt(4)
  ds_read_b128 v[106:109], v11 offset:1056
  v_mfma_f32_16x16x32_bf16 v[166:169], a[96:99], v[86:89], v[166:169]
  buffer_load_dwordx4 v2, s[40:43], s65 offen offset:0 lds
  v_mfma_f32_16x16x32_bf16 v[170:173], a[100:103], v[86:89], v[170:173]
  s_waitcnt lgkmcnt(4)
  v_mul_u32_u24 v12, 288, v12
  v_lshl_add_u32 v12, v9, 3, v12
  v_mfma_f32_16x16x32_bf16 v[166:169], a[104:107], v[90:93], v[166:169]
  s_lshl_b32 s65, s59, 10
  s_add_u32 m0, s65, 57344
  s_add_u32 s65, s65, 36864
  v_mfma_f32_16x16x32_bf16 v[170:173], a[108:111], v[90:93], v[170:173]
  s_waitcnt lgkmcnt(3)
  v_add_u32 v12, s22, v12
  v_mfma_f32_16x16x32_bf16 v[166:169], a[112:115], v[94:97], v[166:169]
  buffer_load_dwordx4 v2, s[40:43], s65 offen offset:0 lds
  v_mfma_f32_16x16x32_bf16 v[170:173], a[116:119], v[94:97], v[170:173]
  s_waitcnt lgkmcnt(2)
  s_mov_b32 m0, 61440
  s_mov_b32 s65, 40960
  v_mfma_f32_16x16x32_bf16 v[166:169], a[120:123], v[98:101], v[166:169]
  ds_read_b64_tr_b16 a[144:145], v18 offset:11264
  v_mfma_f32_16x16x32_bf16 v[170:173], a[124:127], v[98:101], v[170:173]
  s_waitcnt lgkmcnt(2)
  ds_read_b64_tr_b16 a[146:147], v18 offset:15872
  v_mfma_f32_16x16x32_bf16 v[166:169], a[128:131], v[102:105], v[166:169]
  buffer_load_dwordx4 v2, s[40:43], s65 offen offset:0 lds
  v_mfma_f32_16x16x32_bf16 v[170:173], a[132:135], v[102:105], v[170:173]
  s_waitcnt lgkmcnt(2)
  ds_read_b64_tr_b16 a[148:149], v18 offset:48128
  v_mfma_f32_16x16x32_bf16 v[166:169], a[136:139], v[106:109], v[166:169]
  ds_read_b64_tr_b16 a[150:151], v18 offset:52736
  v_mfma_f32_16x16x32_bf16 v[170:173], a[140:143], v[106:109], v[170:173]
  ds_read_b64_tr_b16 a[152:153], v19 offset:11264
  v_mfma_f32_16x16x32_bf16 v[174:177], a[16:19], v[50:53], 0
  ds_read_b64_tr_b16 a[154:155], v19 offset:15872
  v_mfma_f32_16x16x32_bf16 v[178:181], a[20:23], v[50:53], 0
  ds_read_b64_tr_b16 a[156:157], v19 offset:48128
  v_mfma_f32_16x16x32_bf16 v[174:177], a[24:27], v[54:57], v[174:177]
  ds_read_b64_tr_b16 a[158:159], v19 offset:52736
  v_mfma_f32_16x16x32_bf16 v[178:181], a[28:31], v[54:57], v[178:181]
  v_cvt_pk_bf16_f32 v190, v166, v167
  v_cvt_pk_bf16_f32 v191, v168, v169
  v_cvt_pk_bf16_f32 v192, v170, v171
  v_cvt_pk_bf16_f32 v193, v172, v173
  v_mfma_f32_16x16x32_bf16 v[174:177], a[32:35], v[58:61], v[174:177]
  buffer_store_dwordx4 v[190:193], v16, s[32:35], s93 offen offset:0 sc1
  v_mfma_f32_16x16x32_bf16 v[178:181], a[36:39], v[58:61], v[178:181]
  ds_read_b64_tr_b16 v[206:207], v18 offset:20480
  v_mfma_f32_16x16x32_bf16 v[174:177], a[40:43], v[62:65], v[174:177]
  ds_read_b64_tr_b16 a[160:161], v18 offset:11296
  v_mfma_f32_16x16x32_bf16 v[178:181], a[44:47], v[62:65], v[178:181]
  ds_read_b64_tr_b16 a[162:163], v18 offset:15904
  v_mfma_f32_16x16x32_bf16 v[174:177], a[48:51], v[66:69], v[174:177]
  ds_read_b64_tr_b16 a[164:165], v18 offset:48160
  v_mfma_f32_16x16x32_bf16 v[178:181], a[52:55], v[66:69], v[178:181]
L_pad3:
  s_cbranch_execz L_home
  ds_read_b64_tr_b16 a[166:167], v18 offset:52768
  v_mfma_f32_16x16x32_bf16 v[174:177], a[56:59], v[70:73], v[174:177]
  ds_read_b64_tr_b16 a[168:169], v19 offset:11296
  v_mfma_f32_16x16x32_bf16 v[178:181], a[60:63], v[70:73], v[178:181]
  ds_read_b64_tr_b16 a[170:171], v19 offset:15904
  v_mfma_f32_16x16x32_bf16 v[174:177], a[64:67], v[74:77], v[174:177]
  ds_read_b64_tr_b16 a[172:173], v19 offset:48160
  v_mfma_f32_16x16x32_bf16 v[178:181], a[68:71], v[74:77], v[178:181]
  ds_read_b64_tr_b16 a[174:175], v19 offset:52768
  v_mfma_f32_16x16x32_bf16 v[174:177], a[72:75], v[78:81], v[174:177]
  ds_read_b128 v[110:113], v11 offset:1152
  v_mfma_f32_16x16x32_bf16 v[178:181], a[76:79], v[78:81], v[178:181]
  ds_read_b64_tr_b16 v[208:209], v18 offset:20512
  v_mfma_f32_16x16x32_bf16 v[174:177], a[80:83], v[82:85], v[174:177]
  ds_read_b64_tr_b16 a[176:177], v18 offset:11328
  v_mfma_f32_16x16x32_bf16 v[178:181], a[84:87], v[82:85], v[178:181]
  ds_read_b64_tr_b16 a[178:179], v18 offset:15936
  v_mfma_f32_16x16x32_bf16 v[174:177], a[88:91], v[86:89], v[174:177]
  ds_read_b64_tr_b16 a[180:181], v18 offset:48192
  v_mfma_f32_16x16x32_bf16 v[178:181], a[92:95], v[86:89], v[178:181]
  ds_read_b64_tr_b16 a[182:183], v18 offset:52800
  v_mfma_f32_16x16x32_bf16 v[174:177], a[96:99], v[90:93], v[174:177]
  ds_read_b64_tr_b16 a[184:185], v19 offset:11328
  v_mfma_f32_16x16x32_bf16 v[178:181], a[100:103], v[90:93], v[178:181]
  ds_read_b64_tr_b16 a[186:187], v19 offset:15936
  v_mfma_f32_16x16x32_bf16 v[174:177], a[104:107], v[94:97], v[174:177]
  ds_read_b64_tr_b16 a[188:189], v19 offset:48192
  v_mfma_f32_16x16x32_bf16 v[178:181], a[108:111], v[94:97], v[178:181]
  ds_read_b64_tr_b16 a[190:191], v19 offset:52800
  v_mfma_f32_16x16x32_bf16 v[174:177], a[112:115], v[98:101], v[174:177]
  ds_read_b64_tr_b16 v[210:211], v18 offset:20544
  v_mfma_f32_16x16x32_bf16 v[178:181], a[116:119], v[98:101], v[178:181]
  ds_read_b64_tr_b16 a[192:193], v18 offset:11360
  v_mfma_f32_16x16x32_bf16 v[174:177], a[120:123], v[102:105], v[174:177]
  ds_read_b64_tr_b16 a[194:195], v18 offset:15968
  v_mfma_f32_16x16x32_bf16 v[178:181], a[124:127], v[102:105], v[178:181]
  ds_read_b64_tr_b16 a[196:197], v18 offset:48224
  v_mfma_f32_16x16x32_bf16 v[174:177], a[128:131], v[106:109], v[174:177]
  ds_write_b128 v13, v[150:153] offset:0
  v_mfma_f32_16x16x32_bf16 v[178:181], a[132:135], v[106:109], v[178:181]
  s_waitcnt lgkmcnt(9)
  ds_read_b64_tr_b16 a[198:199], v18 offset:52832
  v_mfma_f32_16x16x32_bf16 v[174:177], a[136:139], v[110:113], v[174:177]
  ds_write_b128 v13, v[154:157] offset:1024
  v_mfma_f32_16x16x32_bf16 v[178:181], a[140:143], v[110:113], v[178:181]
  buffer_load_dword v33, v32, s[32:35], 0 offen sc1
  v_mfma_f32_16x16x32_bf16 v[182:185], a[16:19], v[54:57], 0
  ds_write_b128 v13, v[158:161] offset:2048
  v_mfma_f32_16x16x32_bf16 v[186:189], a[20:23], v[54:57], 0
  v_mfma_f32_16x16x32_bf16 v[182:185], a[24:27], v[58:61], v[182:185]
  ds_write_b128 v13, v[162:165] offset:3072
  v_mfma_f32_16x16x32_bf16 v[186:189], a[28:31], v[58:61], v[186:189]
  v_cvt_pk_bf16_f32 v194, v174, v175
  v_cvt_pk_bf16_f32 v195, v176, v177
  v_mfma_f32_16x16x32_bf16 v[182:185], a[32:35], v[62:65], v[182:185]
  ds_read_b64_tr_b16 a[200:201], v19 offset:11360
  v_cvt_pk_bf16_f32 v196, v178, v179
  v_mfma_f32_16x16x32_bf16 v[186:189], a[36:39], v[62:65], v[186:189]
  ds_read_b64_tr_b16 a[202:203], v19 offset:15968
  v_cvt_pk_bf16_f32 v197, v180, v181
  v_mfma_f32_16x16x32_bf16 v[182:185], a[40:43], v[66:69], v[182:185]
  buffer_store_dwordx4 v[194:197], v16, s[32:35], s93 offen offset:1024 sc1
  v_mfma_f32_16x16x32_bf16 v[186:189], a[44:47], v[66:69], v[186:189]
  ds_read_b64_tr_b16 a[204:205], v19 offset:48224
  v_mfma_f32_16x16x32_bf16 v[182:185], a[48:51], v[70:73], v[182:185]
  ds_read_b64_tr_b16 a[206:207], v19 offset:52832
  v_mfma_f32_16x16x32_bf16 v[186:189], a[52:55], v[70:73], v[186:189]
  ds_read_b64_tr_b16 v[212:213], v18 offset:20576
  v_mfma_f32_16x16x32_bf16 v[182:185], a[56:59], v[74:77], v[182:185]
  s_waitcnt lgkmcnt(5)
  s_waitcnt vmcnt(3)
  s_barrier
  v_mfma_f32_16x16x32_bf16 v[186:189], a[60:63], v[74:77], v[186:189]
  ds_read_b128 v[122:125], v14 offset:0
  v_mfma_f32_16x16x32_bf16 v[182:185], a[64:67], v[78:81], v[182:185]
  ds_read_b128 v[126:129], v14 offset:4096
  v_mfma_f32_16x16x32_bf16 v[186:189], a[68:71], v[78:81], v[186:189]
  ds_read_b128 v[130:133], v14 offset:8192
  v_mfma_f32_16x16x32_bf16 v[182:185], a[72:75], v[82:85], v[182:185]
  s_lshl_b32 s64, s59, 10
  s_add_u32 m0, s64, 25600
  s_add_u32 s65, s64, s81
  v_mfma_f32_16x16x32_bf16 v[186:189], a[76:79], v[82:85], v[186:189]
  ds_read_b128 v[134:137], v14 offset:12288
  v_mfma_f32_16x16x32_bf16 v[182:185], a[80:83], v[86:89], v[182:185]
  ds_read_b128 v[114:117], v11 offset:1216
  v_mfma_f32_16x16x32_bf16 v[186:189], a[84:87], v[86:89], v[186:189]
  buffer_load_dwordx4 v2, s[32:35], s65 offen sc1 lds
  v_mfma_f32_16x16x32_bf16 v[182:185], a[88:91], v[90:93], v[182:185]
  s_and_b32 s64, s64, 1024
  s_add_u32 m0, s64, 29696
  s_add_u32 s65, s64, s81
  v_mfma_f32_16x16x32_bf16 v[186:189], a[92:95], v[90:93], v[186:189]
  ds_read_b64_tr_b16 a[208:209], v18 offset:11392
  v_mfma_f32_16x16x32_bf16 v[182:185], a[96:99], v[94:97], v[182:185]
  ds_read_b64_tr_b16 a[210:211], v18 offset:16000
  v_mfma_f32_16x16x32_bf16 v[186:189], a[100:103], v[94:97], v[186:189]
  buffer_load_dwordx4 v3, s[32:35], s65 offen sc1 lds
  v_mfma_f32_16x16x32_bf16 v[182:185], a[104:107], v[98:101], v[182:185]
  s_waitcnt lgkmcnt(5)
  v_add_f32 v122, v122, v126
  v_mfma_f32_16x16x32_bf16 v[186:189], a[108:111], v[98:101], v[186:189]
  s_waitcnt lgkmcnt(3)
  v_add_f32 v130, v130, v134
  v_add_f32 v123, v123, v127
  v_mfma_f32_16x16x32_bf16 v[182:185], a[112:115], v[102:105], v[182:185]
  ds_read_b64_tr_b16 a[212:213], v18 offset:48256
  v_add_f32 v131, v131, v135
  v_mfma_f32_16x16x32_bf16 v[186:189], a[116:119], v[102:105], v[186:189]
  ds_read_b64_tr_b16 a[214:215], v18 offset:52864
  v_add_f32 v124, v124, v128
  v_mfma_f32_16x16x32_bf16 v[182:185], a[120:123], v[106:109], v[182:185]
  ds_read_b64_tr_b16 a[216:217], v19 offset:11392
  v_add_f32 v132, v132, v136
  v_mfma_f32_16x16x32_bf16 v[186:189], a[124:127], v[106:109], v[186:189]
  ds_read_b64_tr_b16 a[218:219], v19 offset:16000
  v_add_f32 v125, v125, v129
  v_mfma_f32_16x16x32_bf16 v[182:185], a[128:131], v[110:113], v[182:185]
  ds_read_b64_tr_b16 a[220:221], v19 offset:48256
  v_add_f32 v133, v133, v137
  v_mfma_f32_16x16x32_bf16 v[186:189], a[132:135], v[110:113], v[186:189]
  s_waitcnt lgkmcnt(6)
  v_add_f32 v122, v122, v130
  v_add_f32 v123, v123, v131
  v_mfma_f32_16x16x32_bf16 v[182:185], a[136:139], v[114:117], v[182:185]
  ds_read_b64_tr_b16 a[222:223], v19 offset:52864
  v_add_f32 v124, v124, v132
  v_mfma_f32_16x16x32_bf16 v[186:189], a[140:143], v[114:117], v[186:189]
  ds_read_b64_tr_b16 v[214:215], v18 offset:20608
  v_add_f32 v125, v125, v133
  v_mfma_f32_16x16x32_bf16 v[166:169], a[16:19], v[58:61], 0
  ds_read_b64_tr_b16 a[224:225], v18 offset:11424
  v_cvt_pk_bf16_f32 v138, v122, v123
  v_mfma_f32_16x16x32_bf16 v[170:173], a[20:23], v[58:61], 0
  ds_read_b64_tr_b16 a[226:227], v18 offset:16032
  v_cvt_pk_bf16_f32 v139, v124, v125
  v_mfma_f32_16x16x32_bf16 v[166:169], a[24:27], v[62:65], v[166:169]
  buffer_store_dwordx2 v[138:139], v17, s[32:35], s19 offen sc1
  v_mfma_f32_16x16x32_bf16 v[170:173], a[28:31], v[62:65], v[170:173]
  v_cvt_pk_bf16_f32 v190, v182, v183
  v_cvt_pk_bf16_f32 v191, v184, v185
  v_cvt_pk_bf16_f32 v192, v186, v187
  v_cvt_pk_bf16_f32 v193, v188, v189
  v_mfma_f32_16x16x32_bf16 v[166:169], a[32:35], v[66:69], v[166:169]
  buffer_store_dwordx4 v[190:193], v16, s[32:35], s93 offen offset:2048 sc1
  v_mfma_f32_16x16x32_bf16 v[170:173], a[36:39], v[66:69], v[170:173]
  ds_read_b64_tr_b16 a[228:229], v18 offset:48288
  s_mul_i32 s63, s59, 288
  v_mfma_f32_16x16x32_bf16 v[166:169], a[40:43], v[70:73], v[166:169]
  ds_read_b64_tr_b16 a[230:231], v18 offset:52896
  v_add_u32 v122, s63, v6
  v_mfma_f32_16x16x32_bf16 v[170:173], a[44:47], v[70:73], v[170:173]
  ds_read_b128 v[122:125], v122
  v_add_u32 v126, s63, v10
  v_mfma_f32_16x16x32_bf16 v[166:169], a[48:51], v[74:77], v[166:169]
  ds_read_b128 v[126:129], v126
  v_add_u32 v130, s63, v20
  v_mfma_f32_16x16x32_bf16 v[170:173], a[52:55], v[74:77], v[170:173]
  ds_read_b128 v[130:133], v130
  v_add_u32 v134, s63, v21
  v_mfma_f32_16x16x32_bf16 v[166:169], a[56:59], v[78:81], v[166:169]
  ds_read_b128 v[134:137], v134
  v_mfma_f32_16x16x32_bf16 v[170:173], a[60:63], v[78:81], v[170:173]
  ds_read_b64_tr_b16 a[232:233], v19 offset:11424
  v_mfma_f32_16x16x32_bf16 v[166:169], a[64:67], v[82:85], v[166:169]
  ds_read_b64_tr_b16 a[234:235], v19 offset:16032
  v_mfma_f32_16x16x32_bf16 v[170:173], a[68:71], v[82:85], v[170:173]
  ds_read_b64_tr_b16 a[236:237], v19 offset:48288
  v_mfma_f32_16x16x32_bf16 v[166:169], a[72:75], v[86:89], v[166:169]
  ds_read_b128 v[118:121], v11 offset:1280
  v_mfma_f32_16x16x32_bf16 v[170:173], a[76:79], v[86:89], v[170:173]
  ds_read_b128 v[46:49], v6 offset:0
  v_mfma_f32_16x16x32_bf16 v[166:169], a[80:83], v[90:93], v[166:169]
  ds_read_b128 v[50:53], v10 offset:0
  v_mfma_f32_16x16x32_bf16 v[170:173], a[84:87], v[90:93], v[170:173]
  ds_read_b128 v[54:57], v20 offset:0
  v_mfma_f32_16x16x32_bf16 v[166:169], a[88:91], v[94:97], v[166:169]
  ds_read_b128 v[58:61], v21 offset:0
  v_mfma_f32_16x16x32_bf16 v[170:173], a[92:95], v[94:97], v[170:173]
  ds_read_b128 v[62:65], v6 offset:288
  v_mfma_f32_16x16x32_bf16 v[166:169], a[96:99], v[98:101], v[166:169]
  ds_read_b128 v[66:69], v10 offset:288
  v_mfma_f32_16x16x32_bf16 v[170:173], a[100:103], v[98:101], v[170:173]
  ds_read_b128 v[70:73], v20 offset:288
  v_mfma_f32_16x16x32_bf16 v[166:169], a[104:107], v[102:105], v[166:169]
  ds_read_b128 v[74:77], v21 offset:288
  v_mfma_f32_16x16x32_bf16 v[170:173], a[108:111], v[102:105], v[170:173]
  s_waitcnt vmcnt(5)
  v_bitop3_b32 v33, v33, s60, v203 bitop3:0x7e
  v_cmp_ne_u32 vcc, 0, v33
  s_nop 0
  s_cbranch_vccnz L_r3
L_r3_back:
  v_mfma_f32_16x16x32_bf16 v[166:169], a[112:115], v[106:109], v[166:169]
  ds_read_b128 v[78:81], v6 offset:576
  v_mfma_f32_16x16x32_bf16 v[170:173], a[116:119], v[106:109], v[170:173]
  ds_read_b128 v[82:85], v10 offset:576
  v_mfma_f32_16x16x32_bf16 v[166:169], a[120:123], v[110:113], v[166:169]
  ds_read_b128 v[86:89], v20 offset:576
  v_mfma_f32_16x16x32_bf16 v[170:173], a[124:127], v[110:113], v[170:173]
  ds_read_b128 v[90:93], v21 offset:576
  v_mfma_f32_16x16x32_bf16 v[166:169], a[128:131], v[114:117], v[166:169]
  ds_read_b128 v[94:97], v6 offset:864
  v_mfma_f32_16x16x32_bf16 v[170:173], a[132:135], v[114:117], v[170:173]
  s_waitcnt lgkmcnt(7)
  ds_read_b128 v[98:101], v10 offset:864
  v_mfma_f32_16x16x32_bf16 v[166:169], a[136:139], v[118:121], v[166:169]
  ds_read_b128 v[102:105], v20 offset:864
  v_mfma_f32_16x16x32_bf16 v[170:173], a[140:143], v[118:121], v[170:173]
  ds_read_b128 v[106:109], v21 offset:864
  v_mfma_f32_16x16x32_bf16 v[198:201], a[0:3], v[122:125], 0
  ds_read_b64_tr_b16 a[238:239], v19 offset:52896
  v_mfma_f32_16x16x32_bf16 v[174:177], a[16:19], v[46:49], 0
  ds_read_b64_tr_b16 a[0:1], v18 offset:0
  v_mfma_f32_16x16x32_bf16 v[178:181], a[20:23], v[46:49], 0
  ds_read_b64_tr_b16 a[2:3], v18 offset:4608
  v_mfma_f32_16x16x32_bf16 v[198:201], a[4:7], v[126:129], v[198:201]
  v_cvt_pk_bf16_f32 v194, v166, v167
  v_cvt_pk_bf16_f32 v195, v168, v169
  v_cvt_pk_bf16_f32 v196, v170, v171
  v_cvt_pk_bf16_f32 v197, v172, v173
  v_mfma_f32_16x16x32_bf16 v[174:177], a[24:27], v[50:53], v[174:177]
  buffer_store_dwordx4 v[194:197], v16, s[32:35], s93 offen offset:3072 sc1
  v_mfma_f32_16x16x32_bf16 v[178:181], a[28:31], v[50:53], v[178:181]
  ds_read_b64_tr_b16 a[4:5], v18 offset:32
  v_mfma_f32_16x16x32_bf16 v[198:201], a[8:11], v[130:133], v[198:201]
  ds_read_b64_tr_b16 a[6:7], v18 offset:4640
  v_mfma_f32_16x16x32_bf16 v[174:177], a[32:35], v[54:57], v[174:177]
  ds_read_b64_tr_b16 a[8:9], v18 offset:64
  v_mfma_f32_16x16x32_bf16 v[178:181], a[36:39], v[54:57], v[178:181]
  ds_read_b64_tr_b16 a[10:11], v18 offset:4672
  ds_read_b64_tr_b16 v[216:217], v18 offset:20640
  v_mfma_f32_16x16x32_bf16 v[198:201], a[12:15], v[134:137], v[198:201]
  ds_read_b64_tr_b16 a[240:241], v18 offset:11456
  ds_read_b64_tr_b16 a[242:243], v18 offset:16064
  v_mfma_f32_16x16x32_bf16 v[174:177], a[40:43], v[58:61], v[174:177]
  ds_read_b64_tr_b16 a[12:13], v18 offset:96
  ds_read_b64_tr_b16 a[14:15], v18 offset:4704
  v_mfma_f32_16x16x32_bf16 v[178:181], a[44:47], v[58:61], v[178:181]
  ds_read_b64_tr_b16 a[16:17], v18 offset:128
  ds_read_b64_tr_b16 a[18:19], v18 offset:4736
  v_mfma_f32_16x16x32_bf16 v[174:177], a[48:51], v[62:65], v[174:177]
  ds_read_b64_tr_b16 a[20:21], v18 offset:160
  ds_read_b64_tr_b16 a[22:23], v18 offset:4768
  v_mfma_f32_16x16x32_bf16 v[178:181], a[52:55], v[62:65], v[178:181]
  s_waitcnt vmcnt(3)
  ds_read_b64_tr_b16 a[24:25], v18 offset:192
  v_cvt_pk_bf16_f32 v198, v198, v199
  v_mfma_f32_16x16x32_bf16 v[174:177], a[56:59], v[66:69], v[174:177]
  ds_read_b64_tr_b16 a[26:27], v18 offset:4800
  ds_read_b64_tr_b16 a[28:29], v18 offset:224
  v_mfma_f32_16x16x32_bf16 v[178:181], a[60:63], v[66:69], v[178:181]
  s_waitcnt lgkmcnt(14)
  ds_read_b64_tr_b16 a[30:31], v18 offset:4832
  v_cvt_pk_bf16_f32 v199, v200, v201
  v_mfma_f32_16x16x32_bf16 v[174:177], a[64:67], v[70:73], v[174:177]
  s_cmp_lt_u32 s59, 2
  s_cbranch_scc0 L_pq0
  buffer_load_dwordx4 v[150:153], v2, s[32:35], s72 offen sc1
  s_add_u32 s61, s72, 4096
  buffer_load_dwordx4 v[154:157], v2, s[32:35], s61 offen sc1
  s_add_u32 s61, s72, 8192
  buffer_load_dwordx4 v[158:161], v2, s[32:35], s61 offen sc1
  s_add_u32 s61, s72, 12288
  buffer_load_dwordx4 v[162:165], v2, s[32:35], s61 offen sc1
  buffer_load_dword v146, v22, s[32:35], s73 offen sc1
  buffer_load_dword v147, v23, s[32:35], s73 offen sc1
L_pq0:
  v_mfma_f32_16x16x32_bf16 v[178:181], a[68:71], v[70:73], v[178:181]
  ds_read_b64_tr_b16 a[32:33], v18 offset:256
  ds_read_b64_tr_b16 a[34:35], v18 offset:4864
  v_mfma_f32_16x16x32_bf16 v[174:177], a[72:75], v[74:77], v[174:177]
  ds_read_b64_tr_b16 a[36:37], v18 offset:36864
  ds_read_b64_tr_b16 a[38:39], v18 offset:41472
  v_mfma_f32_16x16x32_bf16 v[178:181], a[76:79], v[74:77], v[178:181]
  ds_read_b64_tr_b16 a[40:41], v18 offset:36896
  ds_read_b64_tr_b16 a[42:43], v18 offset:41504
  v_mfma_f32_16x16x32_bf16 v[174:177], a[80:83], v[78:81], v[174:177]
  ds_read_b64_tr_b16 a[44:45], v18 offset:36928
  ds_read_b64_tr_b16 a[46:47], v18 offset:41536
  v_mfma_f32_16x16x32_bf16 v[178:181], a[84:87], v[78:81], v[178:181]
  ds_read_b64_tr_b16 a[48:49], v18 offset:36960
  ds_read_b64_tr_b16 a[50:51], v18 offset:41568
  v_mfma_f32_16x16x32_bf16 v[174:177], a[88:91], v[82:85], v[174:177]
  ds_read_b64_tr_b16 a[52:53], v18 offset:36992
  ds_read_b64_tr_b16 a[54:55], v18 offset:41600
  v_mfma_f32_16x16x32_bf16 v[178:181], a[92:95], v[82:85], v[178:181]
  ds_read_b64_tr_b16 a[56:57], v18 offset:37024
  ds_read_b64_tr_b16 a[58:59], v18 offset:41632
  v_mfma_f32_16x16x32_bf16 v[174:177], a[96:99], v[86:89], v[174:177]
  ds_read_b64_tr_b16 a[60:61], v18 offset:37056
  ds_read_b64_tr_b16 a[62:63], v18 offset:41664
  v_mfma_f32_16x16x32_bf16 v[178:181], a[100:103], v[86:89], v[178:181]
  ds_read_b64_tr_b16 a[64:65], v18 offset:37088
  ds_read_b64_tr_b16 a[66:67], v18 offset:41696
  v_mfma_f32_16x16x32_bf16 v[174:177], a[104:107], v[90:93], v[174:177]
  ds_read_b64_tr_b16 a[68:69], v18 offset:37120
  ds_read_b64_tr_b16 a[70:71], v18 offset:41728
  v_mfma_f32_16x16x32_bf16 v[178:181], a[108:111], v[90:93], v[178:181]
  ds_read_b64_tr_b16 a[72:73], v19 offset:0
  ds_read_b64_tr_b16 a[74:75], v19 offset:4608
  v_mfma_f32_16x16x32_bf16 v[174:177], a[112:115], v[94:97], v[174:177]
  ds_read_b64_tr_b16 a[76:77], v19 offset:32
  ds_read_b64_tr_b16 a[78:79], v19 offset:4640
  v_mfma_f32_16x16x32_bf16 v[178:181], a[116:119], v[94:97], v[178:181]
  ds_read_b64_tr_b16 a[80:81], v19 offset:64
  ds_read_b64_tr_b16 a[82:83], v19 offset:4672
  v_mfma_f32_16x16x32_bf16 v[174:177], a[120:123], v[98:101], v[174:177]
  ds_read_b64_tr_b16 a[84:85], v19 offset:96
  ds_read_b64_tr_b16 a[86:87], v19 offset:4704
  v_mfma_f32_16x16x32_bf16 v[178:181], a[124:127], v[98:101], v[178:181]
  ds_read_b64_tr_b16 a[88:89], v19 offset:128
  ds_read_b64_tr_b16 a[90:91], v19 offset:4736
  v_mfma_f32_16x16x32_bf16 v[174:177], a[128:131], v[102:105], v[174:177]
  ds_read_b64_tr_b16 a[92:93], v19 offset:160
  ds_read_b64_tr_b16 a[94:95], v19 offset:4768
  v_mfma_f32_16x16x32_bf16 v[178:181], a[132:135], v[102:105], v[178:181]
  ds_write_b64 v15, v[198:199] offset:4096
  v_mfma_f32_16x16x32_bf16 v[174:177], a[136:139], v[106:109], v[174:177]
  ds_read_b64_tr_b16 a[96:97], v19 offset:192
  ds_read_b64_tr_b16 a[98:99], v19 offset:4800
  v_mfma_f32_16x16x32_bf16 v[178:181], a[140:143], v[106:109], v[178:181]
  ds_read_b64_tr_b16 a[100:101], v19 offset:224
  ds_read_b64_tr_b16 a[102:103], v19 offset:4832
  ds_read_b64_tr_b16 a[104:105], v19 offset:256
  ds_read_b64_tr_b16 a[244:245], v18 offset:48320
  ds_read_b64_tr_b16 a[106:107], v19 offset:4864
  ds_read_b64_tr_b16 a[246:247], v18 offset:52928
  ds_write_b128 v15, v[174:177] offset:0
  s_nop 0
  ds_write_b128 v15, v[178:181] offset:512
  s_waitcnt lgkmcnt(0)
  s_barrier
  ds_read_b64_tr_b16 a[108:109], v19 offset:36864
  ds_read_b64_tr_b16 a[248:249], v19 offset:11456
  ds_read_b64_tr_b16 a[110:111], v19 offset:41472
  ds_read_b64_tr_b16 a[250:251], v19 offset:16064
  ds_read_b64_tr_b16 a[112:113], v19 offset:36896
  ds_read_b64_tr_b16 a[252:253], v19 offset:48320
  ds_read_b64_tr_b16 a[114:115], v19 offset:41504
  ds_read_b64_tr_b16 a[254:255], v19 offset:52928
  ds_read_b64_tr_b16 a[116:117], v19 offset:36928
  ds_read_b128 v[100:103], v31
  ds_read_b32 v148, v205 offset:4096
  v_mov_b32 v149, 0
  ds_read_b64_tr_b16 v[218:219], v18 offset:20672
  v_mov_b32 v184, 0
  v_mov_b32 v185, 0
  ds_read_b64_tr_b16 a[118:119], v19 offset:41536
  s_cmp_ge_u32 s59, 2
  s_cbranch_scc0 L_pq1
  s_waitcnt vmcnt(0)
  buffer_load_dwordx4 v[150:153], v2, s[32:35], s72 offen sc1
  s_add_u32 s61, s72, 4096
  buffer_load_dwordx4 v[154:157], v2, s[32:35], s61 offen sc1
  s_add_u32 s61, s72, 8192
  buffer_load_dwordx4 v[158:161], v2, s[32:35], s61 offen sc1
  s_add_u32 s61, s72, 12288
  buffer_load_dwordx4 v[162:165], v2, s[32:35], s61 offen sc1
  buffer_load_dword v146, v22, s[32:35], s73 offen sc1
  buffer_load_dword v147, v23, s[32:35], s73 offen sc1
L_pq1:
  ds_read_b64_tr_b16 v[224:225], v18 offset:11488
  ds_read_b64_tr_b16 a[120:121], v19 offset:36960
  ds_read_b64_tr_b16 v[226:227], v18 offset:16096
  ds_read_b64_tr_b16 a[122:123], v19 offset:41568
  ds_read_b64_tr_b16 v[228:229], v18 offset:48352
  ds_read_b64_tr_b16 a[124:125], v19 offset:36992
  ds_read_b64_tr_b16 v[230:231], v18 offset:52960
  ds_read_b64_tr_b16 a[126:127], v19 offset:41600
  ds_read_b64_tr_b16 v[232:233], v19 offset:11488
  ds_read_b64_tr_b16 a[128:129], v19 offset:37024
  ds_read_b64_tr_b16 v[234:235], v19 offset:16096
  ds_read_b64_tr_b16 a[130:131], v19 offset:41632
  ds_read_b64_tr_b16 v[236:237], v19 offset:48352
  ds_read_b64_tr_b16 a[132:133], v19 offset:37056
  ds_read_b64_tr_b16 v[238:239], v19 offset:52960
  ds_read_b64_tr_b16 a[134:135], v19 offset:41664
  ds_read_b64_tr_b16 v[220:221], v18 offset:20704
  ds_read_b128 v[110:113], v30 offset:0
  ds_read_b64_tr_b16 a[136:137], v19 offset:37088
  ds_read_b64_tr_b16 v[240:241], v18 offset:11520
  ds_read_b128 v[114:117], v30 offset:512
  ds_read_b64_tr_b16 a[138:139], v19 offset:41696
  ds_read_b64_tr_b16 v[242:243], v18 offset:16128
  ds_read_b128 v[118:121], v30 offset:1024
  ds_read_b64_tr_b16 a[140:141], v19 offset:37120
  ds_read_b64_tr_b16 v[244:245], v18 offset:48384
  ds_read_b128 v[122:125], v30 offset:1536
  ds_read_b64_tr_b16 a[142:143], v19 offset:41728
  ds_read_b64_tr_b16 v[246:247], v18 offset:52992
  ds_read_b128 v[126:129], v30 offset:2048
  ds_read_b64_tr_b16 v[248:249], v19 offset:11520
  ds_read_b128 v[130:133], v30 offset:2560
  ds_read_b64_tr_b16 v[250:251], v19 offset:16128
  ds_read_b128 v[134:137], v30 offset:3072
  ds_read_b64_tr_b16 v[252:253], v19 offset:48384
  ds_read_b128 v[138:141], v30 offset:3584
  ds_read_b64_tr_b16 v[254:255], v19 offset:52992
  ds_read_b128 v[142:145], v30 offset:4096
  s_waitcnt vmcnt(5) lgkmcnt(15)
  v_mfma_f32_16x16x32_bf16 v[192:195], v[34:37], v[150:153], v[100:103]
  s_waitcnt vmcnt(4)
  v_mfma_f32_16x16x32_bf16 v[192:195], v[34:37], v[154:157], v[192:195]
  s_waitcnt vmcnt(3)
  v_mfma_f32_16x16x32_bf16 v[192:195], v[34:37], v[158:161], v[192:195]
  s_waitcnt vmcnt(2)
  v_mfma_f32_16x16x32_bf16 v[192:195], v[34:37], v[162:165], v[192:195]
  s_waitcnt vmcnt(0)
  v_mfma_f32_16x16x32_bf16 v[104:107], v[38:41], v[146:149], 0
  ds_read_b128 v[64:67], v42 offset:30208
  ds_read_b128 v[68:71], v42 offset:30272
  ds_read_b128 v[72:75], v42 offset:30336
  v_mov_b32 v164, 0
  v_mov_b32 v165, 0
  s_nop 2
  v_cmp_u_f32 vcc, v192, v104
  s_nop 0
  s_cbranch_vccnz L_r4
L_r4_back:
  v_pk_mul_f32 v[186:187], v[192:193], v[192:193]
  v_pk_mul_f32 v[188:189], v[194:195], v[194:195]
  v_mul_f32 v190, v104, v104
  v_pk_fma_f32 v[186:187], v[186:187], s[98:99], s[98:99] op_sel:[0,0,1] op_sel_hi:[1,0,1]
  v_pk_fma_f32 v[188:189], v[188:189], s[98:99], s[98:99] op_sel:[0,0,1] op_sel_hi:[1,0,1]
  v_pk_fma_f32 v[190:191], v[190:191], s[98:99], s[98:99] op_sel:[0,0,1] op_sel_hi:[1,0,1]
  v_pk_mul_f32 v[186:187], v[186:187], v[192:193]
  v_pk_mul_f32 v[188:189], v[188:189], v[194:195]
  v_mul_f32 v190, v190, v104
  v_exp_f32 v186, v186
  v_exp_f32 v187, v187
  v_exp_f32 v188, v188
  v_exp_f32 v189, v189
  v_exp_f32 v190, v190
  v_pk_fma_f32 v[186:187], v[186:187], s[100:101], s[100:101]
  v_pk_fma_f32 v[188:189], v[188:189], s[100:101], s[100:101]
  v_fma_f32 v190, v190, s100, s100
  v_rcp_f32 v186, v186
  v_rcp_f32 v187, v187
  v_rcp_f32 v188, v188
  v_rcp_f32 v189, v189
  v_pk_mul_f32 v[192:193], v[192:193], v[186:187]
  v_pk_mul_f32 v[194:195], v[194:195], v[188:189]
  v_cvt_pk_bf16_f32 v192, v192, v193
  v_cvt_pk_bf16_f32 v193, v194, v195
  ds_write_b64 v24, v[192:193]
  v_rcp_f32 v190, v190
  ds_read_b128 v[166:169], v26 offset:0
  v_mul_f32 v104, v104, v190
  v_cvt_pk_bf16_f32 v104, v104, v104
  ds_read_b128 v[170:173], v26 offset:64
  ds_write_b16 v25, v104
  ds_read_b128 v[174:177], v26 offset:128
  ds_read_b128 v[178:181], v26 offset:192
  ds_read_b64 v[182:183], v27
  ds_read_b128 v[76:79], v42 offset:30400
  ds_read_b128 v[80:83], v42 offset:30464
  ds_read_b128 v[84:87], v42 offset:30528
  ds_read_b128 v[88:91], v42 offset:30592
  ds_read_b128 v[92:95], v42 offset:30656
  ds_read_b128 v[96:99], v42 offset:30720
  ds_read_b64_tr_b16 v[222:223], v18 offset:20736
  ds_read_b64_tr_b16 v[44:45], v18 offset:57344
  ds_read_b64_tr_b16 v[46:47], v18 offset:57376
  ds_read_b64_tr_b16 v[48:49], v18 offset:57408
  s_waitcnt lgkmcnt(15)
  v_mfma_f32_16x16x32_bf16 v[110:113], a[144:147], v[166:169], v[110:113]
  s_waitcnt lgkmcnt(14)
  ds_read_b64_tr_b16 v[50:51], v18 offset:57440
  v_mfma_f32_16x16x32_bf16 v[110:113], a[148:151], v[170:173], v[110:113]
  s_waitcnt lgkmcnt(13)
  ds_read_b64_tr_b16 v[52:53], v18 offset:57472
  v_mfma_f32_16x16x32_bf16 v[110:113], a[152:155], v[174:177], v[110:113]
  s_waitcnt lgkmcnt(13)
  ds_read_b64_tr_b16 v[54:55], v18 offset:57504
  v_mfma_f32_16x16x32_bf16 v[110:113], a[156:159], v[178:181], v[110:113]
  s_waitcnt lgkmcnt(13)
  ds_read_b64_tr_b16 v[56:57], v18 offset:57536
  v_mfma_f32_16x16x32_bf16 v[110:113], v[206:209], v[182:185], v[110:113]
  ds_read_b64_tr_b16 v[58:59], v18 offset:57568
  v_mfma_f32_16x16x32_bf16 v[114:117], a[160:163], v[166:169], v[114:117]
  ds_read_b64_tr_b16 v[60:61], v18 offset:57600
  v_mfma_f32_16x16x32_bf16 v[114:117], a[164:167], v[170:173], v[114:117]
  v_exp_f32 v110, v110
  v_mfma_f32_16x16x32_bf16 v[114:117], a[168:171], v[174:177], v[114:117]
  v_exp_f32 v111, v111
  v_mfma_f32_16x16x32_bf16 v[114:117], a[172:175], v[178:181], v[114:117]
  v_exp_f32 v112, v112
  v_mfma_f32_16x16x32_bf16 v[114:117], v[208:211], v[182:185], v[114:117]
  v_exp_f32 v113, v113
  v_mfma_f32_16x16x32_bf16 v[118:121], a[176:179], v[166:169], v[118:121]
  v_fma_f32 v110, v110, -0.5, -0.5
  v_fma_f32 v111, v111, -0.5, -0.5
  v_mfma_f32_16x16x32_bf16 v[118:121], a[180:183], v[170:173], v[118:121]
  v_fma_f32 v112, v112, -0.5, -0.5
  v_fma_f32 v113, v113, -0.5, -0.5
  v_mfma_f32_16x16x32_bf16 v[118:121], a[184:187], v[174:177], v[118:121]
  v_rcp_f32 v110, v110
  v_mfma_f32_16x16x32_bf16 v[118:121], a[188:191], v[178:181], v[118:121]
  v_rcp_f32 v111, v111
  v_mfma_f32_16x16x32_bf16 v[118:121], v[210:213], v[182:185], v[118:121]
  v_rcp_f32 v112, v112
  v_mfma_f32_16x16x32_bf16 v[122:125], a[192:195], v[166:169], v[122:125]
  v_rcp_f32 v113, v113
  v_mfma_f32_16x16x32_bf16 v[122:125], a[196:199], v[170:173], v[122:125]
  v_cvt_pk_bf16_f32 v146, v110, v111
  v_cvt_pk_bf16_f32 v147, v112, v113
  v_mfma_f32_16x16x32_bf16 v[122:125], a[200:203], v[174:177], v[122:125]
  v_exp_f32 v114, v114
  v_mfma_f32_16x16x32_bf16 v[122:125], a[204:207], v[178:181], v[122:125]
  v_exp_f32 v115, v115
  v_exp_f32 v116, v116
  v_exp_f32 v117, v117
  v_fma_f32 v114, v114, -0.5, -0.5
  v_fma_f32 v115, v115, -0.5, -0.5
  v_fma_f32 v116, v116, -0.5, -0.5
  v_fma_f32 v117, v117, -0.5, -0.5
  v_rcp_f32 v114, v114
  v_rcp_f32 v115, v115
  v_rcp_f32 v116, v116
  v_rcp_f32 v117, v117
  v_cvt_pk_bf16_f32 v148, v114, v115
  v_cvt_pk_bf16_f32 v149, v116, v117
  v_mfma_f32_16x16x32_bf16 v[122:125], v[212:215], v[182:185], v[122:125]
  v_exp_f32 v118, v118
  v_mfma_f32_16x16x32_bf16 v[68:71], a[4:7], v[146:149], v[68:71]
  v_exp_f32 v119, v119
  v_mfma_f32_16x16x32_bf16 v[72:75], a[8:11], v[146:149], v[72:75]
  s_waitcnt lgkmcnt(0)
  v_exp_f32 v120, v120
  v_mfma_f32_16x16x32_bf16 v[76:79], a[12:15], v[146:149], v[76:79]
  v_exp_f32 v121, v121
  v_mfma_f32_16x16x32_bf16 v[80:83], a[16:19], v[146:149], v[80:83]
  v_fma_f32 v118, v118, -0.5, -0.5
  v_fma_f32 v119, v119, -0.5, -0.5
  v_mfma_f32_16x16x32_bf16 v[84:87], a[20:23], v[146:149], v[84:87]
  v_fma_f32 v120, v120, -0.5, -0.5
  v_fma_f32 v121, v121, -0.5, -0.5
  v_mfma_f32_16x16x32_bf16 v[88:91], a[24:27], v[146:149], v[88:91]
  v_rcp_f32 v118, v118
  v_mfma_f32_16x16x32_bf16 v[92:95], a[28:31], v[146:149], v[92:95]
  v_rcp_f32 v119, v119
  v_mfma_f32_16x16x32_bf16 v[96:99], a[32:35], v[146:149], v[96:99]
  v_rcp_f32 v120, v120
  v_mfma_f32_16x16x32_bf16 v[64:67], a[0:3], v[146:149], v[64:67]
  v_rcp_f32 v121, v121
  v_mfma_f32_16x16x32_bf16 v[126:129], a[208:211], v[166:169], v[126:129]
  v_cvt_pk_bf16_f32 v150, v118, v119
  v_cvt_pk_bf16_f32 v151, v120, v121
  v_mfma_f32_16x16x32_bf16 v[126:129], a[212:215], v[170:173], v[126:129]
  v_exp_f32 v122, v122
  v_mfma_f32_16x16x32_bf16 v[126:129], a[216:219], v[174:177], v[126:129]
  v_exp_f32 v123, v123
  v_mfma_f32_16x16x32_bf16 v[126:129], a[220:223], v[178:181], v[126:129]
  v_exp_f32 v124, v124
  v_mfma_f32_16x16x32_bf16 v[126:129], v[214:217], v[182:185], v[126:129]
  v_exp_f32 v125, v125
  v_mfma_f32_16x16x32_bf16 v[130:133], a[224:227], v[166:169], v[130:133]
  v_fma_f32 v122, v122, -0.5, -0.5
  v_fma_f32 v123, v123, -0.5, -0.5
  v_mfma_f32_16x16x32_bf16 v[130:133], a[228:231], v[170:173], v[130:133]
  v_fma_f32 v124, v124, -0.5, -0.5
  v_fma_f32 v125, v125, -0.5, -0.5
  v_mfma_f32_16x16x32_bf16 v[130:133], a[232:235], v[174:177], v[130:133]
  v_rcp_f32 v122, v122
  v_mfma_f32_16x16x32_bf16 v[130:133], a[236:239], v[178:181], v[130:133]
L_pad4:
  s_cbranch_execz L_home
  v_rcp_f32 v123, v123
  v_rcp_f32 v124, v124
  v_rcp_f32 v125, v125
  v_cvt_pk_bf16_f32 v152, v122, v123
  v_cvt_pk_bf16_f32 v153, v124, v125
  v_mfma_f32_16x16x32_bf16 v[130:133], v[216:219], v[182:185], v[130:133]
  v_exp_f32 v126, v126
  v_mfma_f32_16x16x32_bf16 v[68:71], a[40:43], v[150:153], v[68:71]
  v_exp_f32 v127, v127
  v_mfma_f32_16x16x32_bf16 v[72:75], a[44:47], v[150:153], v[72:75]
  v_exp_f32 v128, v128
  v_mfma_f32_16x16x32_bf16 v[76:79], a[48:51], v[150:153], v[76:79]
  v_exp_f32 v129, v129
  v_mfma_f32_16x16x32_bf16 v[80:83], a[52:55], v[150:153], v[80:83]
  v_fma_f32 v126, v126, -0.5, -0.5
  v_fma_f32 v127, v127, -0.5, -0.5
  v_mfma_f32_16x16x32_bf16 v[84:87], a[56:59], v[150:153], v[84:87]
  v_fma_f32 v128, v128, -0.5, -0.5
  v_fma_f32 v129, v129, -0.5, -0.5
  v_mfma_f32_16x16x32_bf16 v[88:91], a[60:63], v[150:153], v[88:91]
  v_rcp_f32 v126, v126
  v_mfma_f32_16x16x32_bf16 v[92:95], a[64:67], v[150:153], v[92:95]
  v_rcp_f32 v127, v127
  v_mfma_f32_16x16x32_bf16 v[96:99], a[68:71], v[150:153], v[96:99]
  v_rcp_f32 v128, v128
  v_mfma_f32_16x16x32_bf16 v[64:67], a[36:39], v[150:153], v[64:67]
  v_rcp_f32 v129, v129
  v_mfma_f32_16x16x32_bf16 v[134:137], a[240:243], v[166:169], v[134:137]
  v_cvt_pk_bf16_f32 v154, v126, v127
  v_cvt_pk_bf16_f32 v155, v128, v129
  v_mfma_f32_16x16x32_bf16 v[134:137], a[244:247], v[170:173], v[134:137]
  v_exp_f32 v130, v130
  v_mfma_f32_16x16x32_bf16 v[134:137], a[248:251], v[174:177], v[134:137]
  v_exp_f32 v131, v131
  v_mfma_f32_16x16x32_bf16 v[134:137], a[252:255], v[178:181], v[134:137]
  v_exp_f32 v132, v132
  v_mfma_f32_16x16x32_bf16 v[134:137], v[218:221], v[182:185], v[134:137]
  v_exp_f32 v133, v133
  v_mfma_f32_16x16x32_bf16 v[138:141], v[224:227], v[166:169], v[138:141]
  v_fma_f32 v130, v130, -0.5, -0.5
  v_fma_f32 v131, v131, -0.5, -0.5
  v_mfma_f32_16x16x32_bf16 v[138:141], v[228:231], v[170:173], v[138:141]
  v_fma_f32 v132, v132, -0.5, -0.5
  v_fma_f32 v133, v133, -0.5, -0.5
  v_mfma_f32_16x16x32_bf16 v[138:141], v[232:235], v[174:177], v[138:141]
  v_rcp_f32 v130, v130
  v_mfma_f32_16x16x32_bf16 v[138:141], v[236:239], v[178:181], v[138:141]
  v_rcp_f32 v131, v131
  v_mfma_f32_16x16x32_bf16 v[138:141], v[220:223], v[182:185], v[138:141]
  v_rcp_f32 v132, v132
  v_mfma_f32_16x16x32_bf16 v[142:145], v[240:243], v[166:169], v[142:145]
  v_rcp_f32 v133, v133
  v_mfma_f32_16x16x32_bf16 v[142:145], v[244:247], v[170:173], v[142:145]
  v_cvt_pk_bf16_f32 v156, v130, v131
  v_cvt_pk_bf16_f32 v157, v132, v133
  v_mfma_f32_16x16x32_bf16 v[142:145], v[248:251], v[174:177], v[142:145]
  v_exp_f32 v134, v134
  v_mfma_f32_16x16x32_bf16 v[142:145], v[252:255], v[178:181], v[142:145]
  v_exp_f32 v135, v135
  v_mfma_f32_16x16x32_bf16 v[142:145], v[222:225], v[182:185], v[142:145]
  v_exp_f32 v136, v136
  v_mfma_f32_16x16x32_bf16 v[68:71], a[76:79], v[154:157], v[68:71]
  v_exp_f32 v137, v137
  v_mfma_f32_16x16x32_bf16 v[72:75], a[80:83], v[154:157], v[72:75]
  v_fma_f32 v134, v134, -0.5, -0.5
  v_fma_f32 v135, v135, -0.5, -0.5
  v_mfma_f32_16x16x32_bf16 v[76:79], a[84:87], v[154:157], v[76:79]
  v_fma_f32 v136, v136, -0.5, -0.5
  v_fma_f32 v137, v137, -0.5, -0.5
  v_mfma_f32_16x16x32_bf16 v[80:83], a[88:91], v[154:157], v[80:83]
  v_rcp_f32 v134, v134
  v_mfma_f32_16x16x32_bf16 v[84:87], a[92:95], v[154:157], v[84:87]
  v_rcp_f32 v135, v135
  v_mfma_f32_16x16x32_bf16 v[88:91], a[96:99], v[154:157], v[88:91]
  v_rcp_f32 v136, v136
  v_mfma_f32_16x16x32_bf16 v[92:95], a[100:103], v[154:157], v[92:95]
  v_rcp_f32 v137, v137
  v_mfma_f32_16x16x32_bf16 v[96:99], a[104:107], v[154:157], v[96:99]
  v_cvt_pk_bf16_f32 v158, v134, v135
  v_cvt_pk_bf16_f32 v159, v136, v137
  v_exp_f32 v138, v138
  v_exp_f32 v139, v139
  v_exp_f32 v140, v140
  v_exp_f32 v141, v141
  v_fma_f32 v138, v138, -0.5, -0.5
  v_fma_f32 v139, v139, -0.5, -0.5
  v_fma_f32 v140, v140, -0.5, -0.5
  v_fma_f32 v141, v141, -0.5, -0.5
  v_rcp_f32 v138, v138
  v_rcp_f32 v139, v139
  v_rcp_f32 v140, v140
  v_rcp_f32 v141, v141
  v_cvt_pk_bf16_f32 v160, v138, v139
  v_cvt_pk_bf16_f32 v161, v140, v141
  v_mfma_f32_16x16x32_bf16 v[64:67], a[72:75], v[154:157], v[64:67]
  v_exp_f32 v142, v142
  v_exp_f32 v143, v143
  v_exp_f32 v144, v144
  v_exp_f32 v145, v145
  v_fma_f32 v142, v142, -0.5, -0.5
  v_fma_f32 v143, v143, -0.5, -0.5
  v_fma_f32 v144, v144, -0.5, -0.5
  v_fma_f32 v145, v145, -0.5, -0.5
  v_rcp_f32 v142, v142
  v_rcp_f32 v143, v143
  v_rcp_f32 v144, v144
  v_rcp_f32 v145, v145
  v_cvt_pk_bf16_f32 v162, v142, v143
  v_cvt_pk_bf16_f32 v163, v144, v145
  v_mfma_f32_16x16x32_bf16 v[68:71], a[112:115], v[158:161], v[68:71]
  s_nop 0
  v_mfma_f32_16x16x32_bf16 v[68:71], v[46:49], v[162:165], v[68:71]
  v_mfma_f32_16x16x32_bf16 v[72:75], a[116:119], v[158:161], v[72:75]
  v_mfma_f32_16x16x32_bf16 v[72:75], v[48:51], v[162:165], v[72:75]
  v_cvt_pk_bf16_f32 v168, v68, v69
  v_cvt_pk_bf16_f32 v169, v70, v71
  v_mfma_f32_16x16x32_bf16 v[76:79], a[120:123], v[158:161], v[76:79]
  ds_write_b64 v12, v[168:169] offset:32288
  v_mfma_f32_16x16x32_bf16 v[76:79], v[50:53], v[162:165], v[76:79]
  v_cvt_pk_bf16_f32 v170, v72, v73
  v_cvt_pk_bf16_f32 v171, v74, v75
  v_mfma_f32_16x16x32_bf16 v[80:83], a[124:127], v[158:161], v[80:83]
  ds_write_b64 v12, v[170:171] offset:32320
  v_mfma_f32_16x16x32_bf16 v[80:83], v[52:55], v[162:165], v[80:83]
  v_cvt_pk_bf16_f32 v172, v76, v77
  v_cvt_pk_bf16_f32 v173, v78, v79
  v_mfma_f32_16x16x32_bf16 v[84:87], a[128:131], v[158:161], v[84:87]
  ds_write_b64 v12, v[172:173] offset:32352
  v_mfma_f32_16x16x32_bf16 v[84:87], v[54:57], v[162:165], v[84:87]
  v_cvt_pk_bf16_f32 v174, v80, v81
  v_cvt_pk_bf16_f32 v175, v82, v83
  v_mfma_f32_16x16x32_bf16 v[88:91], a[132:135], v[158:161], v[88:91]
  ds_write_b64 v12, v[174:175] offset:32384
  v_mfma_f32_16x16x32_bf16 v[88:91], v[56:59], v[162:165], v[88:91]
  v_cvt_pk_bf16_f32 v176, v84, v85
  v_cvt_pk_bf16_f32 v177, v86, v87
  v_mfma_f32_16x16x32_bf16 v[92:95], a[136:139], v[158:161], v[92:95]
  ds_write_b64 v12, v[176:177] offset:32416
  v_mfma_f32_16x16x32_bf16 v[92:95], v[58:61], v[162:165], v[92:95]
  ds_read_b128 v[110:113], v29 offset:32896
  v_cvt_pk_bf16_f32 v178, v88, v89
  v_cvt_pk_bf16_f32 v179, v90, v91
  v_mfma_f32_16x16x32_bf16 v[96:99], a[140:143], v[158:161], v[96:99]
  ds_write_b64 v12, v[178:179] offset:32448
  v_mfma_f32_16x16x32_bf16 v[96:99], v[60:63], v[162:165], v[96:99]
  v_cvt_pk_bf16_f32 v180, v92, v93
  v_cvt_pk_bf16_f32 v181, v94, v95
  v_mfma_f32_16x16x32_bf16 v[64:67], a[108:111], v[158:161], v[64:67]
  ds_write_b64 v12, v[180:181] offset:32480
  v_mfma_f32_16x16x32_bf16 v[64:67], v[44:47], v[162:165], v[64:67]
  ds_read_b128 v[114:117], v29 offset:32384
  v_cvt_pk_bf16_f32 v182, v96, v97
  v_cvt_pk_bf16_f32 v183, v98, v99
  ds_write_b64 v12, v[182:183] offset:32512
  s_waitcnt lgkmcnt(4)
  buffer_store_dwordx4 v[110:113], v28, s[44:47], 0 offen offset:640 sc1
  s_nop 1
  v_cvt_pk_bf16_f32 v166, v64, v65
  v_cvt_pk_bf16_f32 v167, v66, v67
  ds_write_b64 v12, v[166:167] offset:32256
  ds_read_b128 v[118:121], v29 offset:33024
  ds_read_b128 v[122:125], v29 offset:32512
  ds_read_b128 v[126:129], v29 offset:32256
  s_waitcnt lgkmcnt(5)
  buffer_store_dwordx4 v[114:117], v28, s[44:47], 0 offen offset:128 sc1
  s_waitcnt lgkmcnt(2)
  buffer_store_dwordx4 v[118:121], v28, s[44:47], 0 offen offset:768 sc1
  s_waitcnt lgkmcnt(1)
  buffer_store_dwordx4 v[122:125], v28, s[44:47], 0 offen offset:256 sc1
  s_mov_b32 exec_lo, 0
  s_waitcnt lgkmcnt(0)
  buffer_store_dwordx4 v[126:129], v28, s[44:47], 0 offen offset:0 sc1
  s_or_b32 s61, s56, s55
  s_or_b32 s61, s61, s59
  s_cmp_eq_u32 s61, 0
  s_cbranch_scc0 L_ne
  s_mov_b64 exec, 1
  v_mov_b32 v33, s60
  buffer_store_dword v33, off, s[32:35], 0 sc1
  s_mov_b64 exec, -1
L_ne:
L_exit:
  s_endpgm
L_r1_0:
  s_nop 7
  s_add_u32 s23, s70, 0
  buffer_load_dwordx4 v[142:145], v2, s[32:35], s23 offen offset:0 sc1
  buffer_load_dwordx4 v[146:149], v2, s[32:35], s23 offen offset:1024 sc1
  buffer_load_dwordx4 v[150:153], v2, s[32:35], s23 offen offset:2048 sc1
  buffer_load_dwordx4 v[154:157], v2, s[32:35], s23 offen offset:3072 sc1
  buffer_load_dwordx4 v[158:161], v3, s[32:35], s23 offen offset:0 sc1
  buffer_load_dword v202, v4, s[32:35], s23 offen sc1
  s_add_u32 s23, s70, 21504
  buffer_load_dwordx4 v[162:165], v2, s[32:35], s23 offen offset:0 sc1
  buffer_load_dwordx4 v[166:169], v2, s[32:35], s23 offen offset:1024 sc1
  buffer_load_dwordx4 v[170:173], v2, s[32:35], s23 offen offset:2048 sc1
  buffer_load_dwordx4 v[174:177], v2, s[32:35], s23 offen offset:3072 sc1
  buffer_load_dwordx4 v[178:181], v3, s[32:35], s23 offen offset:0 sc1
  buffer_load_dword v203, v4, s[32:35], s23 offen sc1
  s_waitcnt vmcnt(0)
  v_add3_u32 v33, v142, v143, s60
  v_add3_u32 v33, v144, v145, v33
  v_add3_u32 v33, v146, v147, v33
  v_add3_u32 v33, v148, v149, v33
  v_add3_u32 v33, v150, v151, v33
  v_add3_u32 v33, v152, v153, v33
  v_add3_u32 v33, v154, v155, v33
  v_add3_u32 v33, v156, v157, v33
  v_add3_u32 v33, v158, v159, v33
  v_add3_u32 v33, v160, v161, v33
  v_cmp_ne_u32 vcc, v33, v202
  s_add_u32 s80, s80, 1
  s_cbranch_vccz L_r1_0_again
  s_cmp_lt_u32 s80, 20000
  s_cbranch_scc1 L_r1_0
L_r1_0_again:
  v_mfma_f32_16x16x32_bf16 a[144:147], v[142:145], v[46:49], 0
  v_mfma_f32_16x16x32_bf16 a[148:151], v[142:145], v[50:53], 0
  v_mfma_f32_16x16x32_bf16 a[152:155], v[142:145], v[54:57], 0
  v_mfma_f32_16x16x32_bf16 a[156:159], v[142:145], v[58:61], 0
  v_mfma_f32_16x16x32_bf16 a[160:163], v[142:145], v[62:65], 0
  v_mfma_f32_16x16x32_bf16 a[164:167], v[142:145], v[66:69], 0
  v_mfma_f32_16x16x32_bf16 a[168:171], v[142:145], v[70:73], 0
  v_mfma_f32_16x16x32_bf16 a[172:175], v[142:145], v[74:77], 0
  v_mfma_f32_16x16x32_bf16 a[176:179], v[142:145], v[78:81], 0
  v_mfma_f32_16x16x32_bf16 a[180:183], v[142:145], v[82:85], 0
  v_mfma_f32_16x16x32_bf16 a[184:187], v[142:145], v[86:89], 0
  v_mfma_f32_16x16x32_bf16 a[144:147], v[146:149], v[50:53], a[144:147]
  v_mfma_f32_16x16x32_bf16 a[148:151], v[146:149], v[54:57], a[148:151]
  v_mfma_f32_16x16x32_bf16 a[152:155], v[146:149], v[58:61], a[152:155]
  v_mfma_f32_16x16x32_bf16 a[156:159], v[146:149], v[62:65], a[156:159]
  v_mfma_f32_16x16x32_bf16 a[160:163], v[146:149], v[66:69], a[160:163]
  v_mfma_f32_16x16x32_bf16 a[164:167], v[146:149], v[70:73], a[164:167]
  v_mfma_f32_16x16x32_bf16 a[168:171], v[146:149], v[74:77], a[168:171]
  v_mfma_f32_16x16x32_bf16 a[172:175], v[146:149], v[78:81], a[172:175]
  v_mfma_f32_16x16x32_bf16 a[176:179], v[146:149], v[82:85], a[176:179]
  v_mfma_f32_16x16x32_bf16 a[180:183], v[146:149], v[86:89], a[180:183]
  v_mfma_f32_16x16x32_bf16 a[184:187], v[146:149], v[90:93], a[184:187]
  v_mfma_f32_16x16x32_bf16 a[144:147], v[150:153], v[54:57], a[144:147]
  v_mfma_f32_16x16x32_bf16 a[148:151], v[150:153], v[58:61], a[148:151]
  v_mfma_f32_16x16x32_bf16 a[152:155], v[150:153], v[62:65], a[152:155]
  v_mfma_f32_16x16x32_bf16 a[156:159], v[150:153], v[66:69], a[156:159]
  v_mfma_f32_16x16x32_bf16 a[160:163], v[150:153], v[70:73], a[160:163]
  v_mfma_f32_16x16x32_bf16 a[164:167], v[150:153], v[74:77], a[164:167]
  v_mfma_f32_16x16x32_bf16 a[168:171], v[150:153], v[78:81], a[168:171]
  v_mfma_f32_16x16x32_bf16 a[172:175], v[150:153], v[82:85], a[172:175]
  v_mfma_f32_16x16x32_bf16 a[176:179], v[150:153], v[86:89], a[176:179]
  v_mfma_f32_16x16x32_bf16 a[180:183], v[150:153], v[90:93], a[180:183]
  v_mfma_f32_16x16x32_bf16 a[184:187], v[150:153], v[94:97], a[184:187]
  s_nop 7
  s_branch L_r1_0_back
L_r1_1:
  s_nop 7
  s_add_u32 s23, s70, 21504
  buffer_load_dwordx4 v[162:165], v2, s[32:35], s23 offen offset:0 sc1
  buffer_load_dwordx4 v[166:169], v2, s[32:35], s23 offen offset:1024 sc1
  buffer_load_dwordx4 v[170:173], v2, s[32:35], s23 offen offset:2048 sc1
  buffer_load_dwordx4 v[174:177], v2, s[32:35], s23 offen offset:3072 sc1
  buffer_load_dwordx4 v[178:181], v3, s[32:35], s23 offen offset:0 sc1
  buffer_load_dword v203, v4, s[32:35], s23 offen sc1
  s_add_u32 s23, s70, 43008
  buffer_load_dwordx4 v[182:185], v2, s[32:35], s23 offen offset:0 sc1
  buffer_load_dwordx4 v[186:189], v2, s[32:35], s23 offen offset:1024 sc1
  buffer_load_dwordx4 v[190:193], v2, s[32:35], s23 offen offset:2048 sc1
  buffer_load_dwordx4 v[194:197], v2, s[32:35], s23 offen offset:3072 sc1
  buffer_load_dwordx4 v[198:201], v3, s[32:35], s23 offen offset:0 sc1
  buffer_load_dword v204, v4, s[32:35], s23 offen sc1
  s_waitcnt vmcnt(0)
  v_add3_u32 v33, v162, v163, s60
  v_add3_u32 v33, v164, v165, v33
  v_add3_u32 v33, v166, v167, v33
  v_add3_u32 v33, v168, v169, v33
  v_add3_u32 v33, v170, v171, v33
  v_add3_u32 v33, v172, v173, v33
  v_add3_u32 v33, v174, v175, v33
  v_add3_u32 v33, v176, v177, v33
  v_add3_u32 v33, v178, v179, v33
  v_add3_u32 v33, v180, v181, v33
  v_cmp_ne_u32 vcc, v33, v203
  s_add_u32 s80, s80, 1
  s_cbranch_vccz L_r1_1_back
  s_cmp_lt_u32 s80, 20000
  s_cbranch_scc1 L_r1_1
  s_branch L_r1_1_back
L_r1_2:
  s_nop 7
  s_add_u32 s23, s70, 43008
  buffer_load_dwordx4 v[182:185], v2, s[32:35], s23 offen offset:0 sc1
  buffer_load_dwordx4 v[186:189], v2, s[32:35], s23 offen offset:1024 sc1
  buffer_load_dwordx4 v[190:193], v2, s[32:35], s23 offen offset:2048 sc1
  buffer_load_dwordx4 v[194:197], v2, s[32:35], s23 offen offset:3072 sc1
  buffer_load_dwordx4 v[198:201], v3, s[32:35], s23 offen offset:0 sc1
  buffer_load_dword v204, v4, s[32:35], s23 offen sc1
  s_add_u32 s23, s70, 64512
  buffer_load_dwordx4 v[142:145], v2, s[32:35], s23 offen offset:0 sc1
  buffer_load_dwordx4 v[146:149], v2, s[32:35], s23 offen offset:1024 sc1
  buffer_load_dwordx4 v[150:153], v2, s[32:35], s23 offen offset:2048 sc1
  buffer_load_dwordx4 v[154:157], v2, s[32:35], s23 offen offset:3072 sc1
  buffer_load_dwordx4 v[158:161], v3, s[32:35], s23 offen offset:0 sc1
  buffer_load_dword v202, v4, s[32:35], s23 offen sc1
  s_waitcnt vmcnt(0)
  v_add3_u32 v33, v182, v183, s60
  v_add3_u32 v33, v184, v185, v33
  v_add3_u32 v33, v186, v187, v33
  v_add3_u32 v33, v188, v189, v33
  v_add3_u32 v33, v190, v191, v33
  v_add3_u32 v33, v192, v193, v33
  v_add3_u32 v33, v194, v195, v33
  v_add3_u32 v33, v196, v197, v33
  v_add3_u32 v33, v198, v199, v33
  v_add3_u32 v33, v200, v201, v33
  v_cmp_ne_u32 vcc, v33, v204
  s_add_u32 s80, s80, 1
  s_cbranch_vccz L_r1_2_back
  s_cmp_lt_u32 s80, 20000
  s_cbranch_scc1 L_r1_2
  s_branch L_r1_2_back
L_r1_3:
  s_nop 7
  s_add_u32 s23, s70, 64512
  buffer_load_dwordx4 v[142:145], v2, s[32:35], s23 offen offset:0 sc1
  buffer_load_dwordx4 v[146:149], v2, s[32:35], s23 offen offset:1024 sc1
  buffer_load_dwordx4 v[150:153], v2, s[32:35], s23 offen offset:2048 sc1
  buffer_load_dwordx4 v[154:157], v2, s[32:35], s23 offen offset:3072 sc1
  buffer_load_dwordx4 v[158:161], v3, s[32:35], s23 offen offset:0 sc1
  buffer_load_dword v202, v4, s[32:35], s23 offen sc1
  s_add_u32 s23, s70, 86016
  buffer_load_dwordx4 v[162:165], v2, s[32:35], s23 offen offset:0 sc1
  buffer_load_dwordx4 v[166:169], v2, s[32:35], s23 offen offset:1024 sc1
  buffer_load_dwordx4 v[170:173], v2, s[32:35], s23 offen offset:2048 sc1
  buffer_load_dwordx4 v[174:177], v2, s[32:35], s23 offen offset:3072 sc1
  buffer_load_dwordx4 v[178:181], v3, s[32:35], s23 offen offset:0 sc1
  buffer_load_dword v203, v4, s[32:35], s23 offen sc1
  s_waitcnt vmcnt(0)
  v_add3_u32 v33, v142, v143, s60
  v_add3_u32 v33, v144, v145, v33
  v_add3_u32 v33, v146, v147, v33
  v_add3_u32 v33, v148, v149, v33
  v_add3_u32 v33, v150, v151, v33
  v_add3_u32 v33, v152, v153, v33
  v_add3_u32 v33, v154, v155, v33
  v_add3_u32 v33, v156, v157, v33
  v_add3_u32 v33, v158, v159, v33
  v_add3_u32 v33, v160, v161, v33
  v_cmp_ne_u32 vcc, v33, v202
  s_add_u32 s80, s80, 1
  s_cbranch_vccz L_r1_3_back
  s_cmp_lt_u32 s80, 20000
  s_cbranch_scc1 L_r1_3
  s_branch L_r1_3_back
L_r1_4:
  s_nop 7
  s_add_u32 s23, s70, 86016
  buffer_load_dwordx4 v[162:165], v2, s[32:35], s23 offen offset:0 sc1
  buffer_load_dwordx4 v[166:169], v2, s[32:35], s23 offen offset:1024 sc1
  buffer_load_dwordx4 v[170:173], v2, s[32:35], s23 offen offset:2048 sc1
  buffer_load_dwordx4 v[174:177], v2, s[32:35], s23 offen offset:3072 sc1
  buffer_load_dwordx4 v[178:181], v3, s[32:35], s23 offen offset:0 sc1
  buffer_load_dword v203, v4, s[32:35], s23 offen sc1
  s_add_u32 s23, s70, 107520
  buffer_load_dwordx4 v[182:185], v2, s[32:35], s23 offen offset:0 sc1
  buffer_load_dwordx4 v[186:189], v2, s[32:35], s23 offen offset:1024 sc1
  buffer_load_dwordx4 v[190:193], v2, s[32:35], s23 offen offset:2048 sc1
  buffer_load_dwordx4 v[194:197], v2, s[32:35], s23 offen offset:3072 sc1
  buffer_load_dwordx4 v[198:201], v3, s[32:35], s23 offen offset:0 sc1
  buffer_load_dword v204, v4, s[32:35], s23 offen sc1
  s_waitcnt vmcnt(0)
  v_add3_u32 v33, v162, v163, s60
  v_add3_u32 v33, v164, v165, v33
  v_add3_u32 v33, v166, v167, v33
  v_add3_u32 v33, v168, v169, v33
  v_add3_u32 v33, v170, v171, v33
  v_add3_u32 v33, v172, v173, v33
  v_add3_u32 v33, v174, v175, v33
  v_add3_u32 v33, v176, v177, v33
  v_add3_u32 v33, v178, v179, v33
  v_add3_u32 v33, v180, v181, v33
  v_cmp_ne_u32 vcc, v33, v203
  s_add_u32 s80, s80, 1
  s_cbranch_vccz L_r1_4_back
  s_cmp_lt_u32 s80, 20000
  s_cbranch_scc1 L_r1_4
  s_branch L_r1_4_back
L_r1_5:
  s_nop 7
  s_add_u32 s23, s70, 107520
  buffer_load_dwordx4 v[182:185], v2, s[32:35], s23 offen offset:0 sc1
  buffer_load_dwordx4 v[186:189], v2, s[32:35], s23 offen offset:1024 sc1
  buffer_load_dwordx4 v[190:193], v2, s[32:35], s23 offen offset:2048 sc1
  buffer_load_dwordx4 v[194:197], v2, s[32:35], s23 offen offset:3072 sc1
  buffer_load_dwordx4 v[198:201], v3, s[32:35], s23 offen offset:0 sc1
  buffer_load_dword v204, v4, s[32:35], s23 offen sc1
  s_add_u32 s23, s70, 129024
  buffer_load_dwordx4 v[142:145], v2, s[32:35], s23 offen offset:0 sc1
  buffer_load_dwordx4 v[146:149], v2, s[32:35], s23 offen offset:1024 sc1
  buffer_load_dwordx4 v[150:153], v2, s[32:35], s23 offen offset:2048 sc1
  buffer_load_dwordx4 v[154:157], v2, s[32:35], s23 offen offset:3072 sc1
  buffer_load_dwordx4 v[158:161], v3, s[32:35], s23 offen offset:0 sc1
  buffer_load_dword v202, v4, s[32:35], s23 offen sc1
  s_waitcnt vmcnt(0)
  v_add3_u32 v33, v182, v183, s60
  v_add3_u32 v33, v184, v185, v33
  v_add3_u32 v33, v186, v187, v33
  v_add3_u32 v33, v188, v189, v33
  v_add3_u32 v33, v190, v191, v33
  v_add3_u32 v33, v192, v193, v33
  v_add3_u32 v33, v194, v195, v33
  v_add3_u32 v33, v196, v197, v33
  v_add3_u32 v33, v198, v199, v33
  v_add3_u32 v33, v200, v201, v33
  v_cmp_ne_u32 vcc, v33, v204
  s_add_u32 s80, s80, 1
  s_cbranch_vccz L_r1_5_back
  s_cmp_lt_u32 s80, 20000
  s_cbranch_scc1 L_r1_5
  s_branch L_r1_5_back
L_r1_6:
  s_nop 7
  s_add_u32 s23, s70, 129024
  buffer_load_dwordx4 v[142:145], v2, s[32:35], s23 offen offset:0 sc1
  buffer_load_dwordx4 v[146:149], v2, s[32:35], s23 offen offset:1024 sc1
  buffer_load_dwordx4 v[150:153], v2, s[32:35], s23 offen offset:2048 sc1
  buffer_load_dwordx4 v[154:157], v2, s[32:35], s23 offen offset:3072 sc1
  buffer_load_dwordx4 v[158:161], v3, s[32:35], s23 offen offset:0 sc1
  buffer_load_dword v202, v4, s[32:35], s23 offen sc1
  s_waitcnt vmcnt(0)
  v_add3_u32 v33, v142, v143, s60
  v_add3_u32 v33, v144, v145, v33
  v_add3_u32 v33, v146, v147, v33
  v_add3_u32 v33, v148, v149, v33
  v_add3_u32 v33, v150, v151, v33
  v_add3_u32 v33, v152, v153, v33
  v_add3_u32 v33, v154, v155, v33
  v_add3_u32 v33, v156, v157, v33
  v_add3_u32 v33, v158, v159, v33
  v_add3_u32 v33, v160, v161, v33
  v_cmp_ne_u32 vcc, v33, v202
  s_add_u32 s80, s80, 1
  s_cbranch_vccz L_r1_6_back
  s_cmp_lt_u32 s80, 20000
  s_cbranch_scc1 L_r1_6
  s_branch L_r1_6_back
L_padr:
  s_branch L_home
L_r3:
  s_nop 7
  buffer_load_dword v33, v32, s[32:35], 0 offen sc1
  s_waitcnt vmcnt(0)
  v_cmp_ne_u32 vcc, s60, v33
  s_add_u32 s80, s80, 1
  s_cbranch_vccz L_r3_again
  s_cmp_lt_u32 s80, 20000
  s_cbranch_scc1 L_r3
L_r3_again:
  v_cmp_ne_u32 vcc, s60, v203
  s_nop 0
  s_cbranch_vccz L_r3_back
  s_lshl_b32 s64, s59, 10
  s_add_u32 m0, s64, 25600
  s_add_u32 s65, s64, s81
  buffer_load_dwordx4 v2, s[32:35], s65 offen sc1 lds
  s_and_b32 s64, s64, 1024
  s_add_u32 m0, s64, 29696
  s_add_u32 s65, s64, s81
  buffer_load_dwordx4 v3, s[32:35], s65 offen sc1 lds
  s_waitcnt vmcnt(0)
  s_nop 7
  s_branch L_r3_back
L_r4:
  s_nop 7
  buffer_load_dwordx4 v[150:153], v2, s[32:35], s72 offen sc1
  s_add_u32 s61, s72, 4096
  buffer_load_dwordx4 v[154:157], v2, s[32:35], s61 offen sc1
  s_add_u32 s61, s72, 8192
  buffer_load_dwordx4 v[158:161], v2, s[32:35], s61 offen sc1
  s_add_u32 s61, s72, 12288
  buffer_load_dwordx4 v[162:165], v2, s[32:35], s61 offen sc1
  buffer_load_dword v146, v22, s[32:35], s73 offen sc1
  buffer_load_dword v147, v23, s[32:35], s73 offen sc1
  s_waitcnt vmcnt(0)
  v_max_u32 v33, v150, v151
  v_max3_u32 v33, v33, v152, v153
  v_max3_u32 v33, v33, v154, v155
  v_max3_u32 v33, v33, v156, v157
  v_max3_u32 v33, v33, v158, v159
  v_max3_u32 v33, v33, v160, v161
  v_max3_u32 v33, v33, v162, v163
  v_max3_u32 v33, v33, v164, v165
  v_max3_u32 v33, v33, v146, v147
  v_cmp_eq_u32 vcc, -1, v33
  s_add_u32 s80, s80, 1
  s_cbranch_vccz L_r4_again
  s_cmp_lt_u32 s80, 20000
  s_cbranch_scc1 L_r4
L_r4_again:
  v_mfma_f32_16x16x32_bf16 v[192:195], v[34:37], v[150:153], v[100:103]
  v_mfma_f32_16x16x32_bf16 v[192:195], v[34:37], v[154:157], v[192:195]
  v_mfma_f32_16x16x32_bf16 v[192:195], v[34:37], v[158:161], v[192:195]
  v_mfma_f32_16x16x32_bf16 v[192:195], v[34:37], v[162:165], v[192:195]
  v_mfma_f32_16x16x32_bf16 v[104:107], v[38:41], v[146:149], 0
  v_mov_b32 v164, 0
  v_mov_b32 v165, 0
  s_nop 7
  s_branch L_r4_back
L_spare:
  s_load_dword s60, s[22:23], 0
  s_mov_b32 s32, s22
  s_mov_b32 s33, s23
  s_mov_b32 s34, 268435456
  s_mov_b32 s35, 0x20000
  s_mov_b32 s44, s12
  s_mov_b32 s45, s13
  s_mov_b32 s46, 41472
  s_mov_b32 s47, 0x20000
  s_mul_i32 s61, s54, 81
  v_min_u32 v253, 80, v0
  v_add_lshl_u32 v253, v253, s61, 7
  s_mov_b32 s48, s16
  s_mov_b32 s49, s17
  s_mov_b32 s50, 41472
  s_mov_b32 s51, 0x20000
  s_mov_b32 s36, s14
  s_mov_b32 s37, s15
  s_mov_b32 s38, 41472
  s_mov_b32 s39, 0x20000
  s_mov_b32 s40, s10
  s_mov_b32 s41, s11
  s_mov_b32 s42, 4608
  s_mov_b32 s43, 0x20000
  s_mul_i32 s64, s59, 11264
  s_add_u32 s65, s64, 0
  s_add_u32 m0, s64, 0
  s_nop 0
  buffer_load_dwordx4 v2, s[36:39], s65 offen offset:0 lds
  buffer_load_dwordx4 v2, s[36:39], s65 offen offset:1024 lds
  buffer_load_dwordx4 v2, s[36:39], s65 offen offset:2048 lds
  buffer_load_dwordx4 v2, s[36:39], s65 offen offset:3072 lds
  s_add_u32 s65, s64, 4096
  s_add_u32 m0, s64, 4096
  s_nop 0
  buffer_load_dwordx4 v2, s[36:39], s65 offen offset:0 lds
  buffer_load_dwordx4 v2, s[36:39], s65 offen offset:1024 lds
  buffer_load_dwordx4 v2, s[36:39], s65 offen offset:2048 lds
  buffer_load_dwordx4 v2, s[36:39], s65 offen offset:3072 lds
  s_add_u32 s65, s64, 8192
  s_add_u32 m0, s64, 8192
  s_nop 0
  buffer_load_dwordx4 v2, s[36:39], s65 offen offset:0 lds
  buffer_load_dwordx4 v2, s[36:39], s65 offen offset:1024 lds
  buffer_load_dwordx4 v2, s[36:39], s65 offen offset:2048 lds
  v_and_b32 v46, 7, v1
  v_lshrrev_b32 v47, 4, v1
  v_mul_u32_u24 v48, 288, v46
  v_lshl_add_u32 v48, v47, 3, v48
  s_mul_i32 s61, s57, 2304
  buffer_load_dwordx2 v[60:61], v48, s[40:43], s61 offen offset:0
  buffer_load_dwordx2 v[62:63], v48, s[40:43], s61 offen offset:32
  buffer_load_dwordx2 v[64:65], v48, s[40:43], s61 offen offset:64
  buffer_load_dwordx2 v[66:67], v48, s[40:43], s61 offen offset:96
  buffer_load_dwordx2 v[68:69], v48, s[40:43], s61 offen offset:128
  buffer_load_dwordx2 v[70:71], v48, s[40:43], s61 offen offset:160
  buffer_load_dwordx2 v[72:73], v48, s[40:43], s61 offen offset:192
  buffer_load_dwordx2 v[74:75], v48, s[40:43], s61 offen offset:224
  buffer_load_dwordx2 v[76:77], v48, s[40:43], s61 offen offset:256
  buffer_load_dword v252, v253, s[44:47], 0 offen
  s_add_u32 s65, s64, 0
  s_add_u32 m0, s64, 45056
  s_nop 0
  buffer_load_dwordx4 v2, s[48:51], s65 offen offset:0 lds
  buffer_load_dwordx4 v2, s[48:51], s65 offen offset:1024 lds
  buffer_load_dwordx4 v2, s[48:51], s65 offen offset:2048 lds
  buffer_load_dwordx4 v2, s[48:51], s65 offen offset:3072 lds
  s_add_u32 s65, s64, 4096
  s_add_u32 m0, s64, 49152
  s_nop 0
  buffer_load_dwordx4 v2, s[48:51], s65 offen offset:0 lds
  buffer_load_dwordx4 v2, s[48:51], s65 offen offset:1024 lds
  buffer_load_dwordx4 v2, s[48:51], s65 offen offset:2048 lds
  buffer_load_dwordx4 v2, s[48:51], s65 offen offset:3072 lds
  s_add_u32 s65, s64, 8192
  s_add_u32 m0, s64, 53248
  s_nop 0
  buffer_load_dwordx4 v2, s[48:51], s65 offen offset:0 lds
  buffer_load_dwordx4 v2, s[48:51], s65 offen offset:1024 lds
  buffer_load_dwordx4 v2, s[48:51], s65 offen offset:2048 lds
  v_lshrrev_b32 v49, 2, v1
  v_mul_u32_u24 v49, 288, v49
  v_and_b32 v50, 3, v1
  v_lshl_add_u32 v49, v50, 3, v49
  s_lshl_b32 s62, s59, 5
  v_add_u32 v49, s62, v49
  v_lshlrev_b32 v51, 4, v46
  v_lshl_add_u32 v51, v47, 7, v51
  s_mul_i32 s63, s54, 6144
  s_add_u32 s63, s63, 131072
  s_lshl_b32 s62, s59, 6
  s_add_u32 s67, s63, s62
  s_add_u32 s67, s67, 4096
  v_lshlrev_b32 v54, 4, v47
  v_add_u32 v55, 45056, v49
  v_mov_b32 v56, 0x3f803f80
  v_mov_b32 v57, v56
  v_mov_b32 v58, v56
  v_mov_b32 v59, v56
  s_lshl_b32 s62, s59, 9
  s_add_u32 s63, s63, s62
  s_mov_b32 s66, s59
  s_waitcnt lgkmcnt(0)
  s_mul_i32 s60, s60, 1664525
  s_add_u32 s60, s60, 1013904223
  v_mov_b32 v52, s60
  s_waitcnt vmcnt(0)
  s_barrier
L_sp1:
  ds_read_b64_tr_b16 v[80:81], v49 offset:0
  ds_read_b64_tr_b16 v[82:83], v49 offset:4608
  ds_read_b64_tr_b16 v[84:85], v49 offset:9216
  ds_read_b64_tr_b16 v[86:87], v49 offset:13824
  ds_read_b64_tr_b16 v[88:89], v49 offset:18432
  ds_read_b64_tr_b16 v[90:91], v49 offset:23040
  ds_read_b64_tr_b16 v[92:93], v49 offset:27648
  ds_read_b64_tr_b16 v[94:95], v49 offset:32256
  ds_read_b64_tr_b16 v[96:97], v49 offset:36864
  s_waitcnt lgkmcnt(7)
  v_mfma_f32_16x16x32_bf16 v[100:103], v[80:83], v[60:63], 0
  s_waitcnt lgkmcnt(5)
  v_mfma_f32_16x16x32_bf16 v[100:103], v[84:87], v[64:67], v[100:103]
  s_waitcnt lgkmcnt(3)
  v_mfma_f32_16x16x32_bf16 v[100:103], v[88:91], v[68:71], v[100:103]
  s_waitcnt lgkmcnt(1)
  v_mfma_f32_16x16x32_bf16 v[100:103], v[92:95], v[72:75], v[100:103]
  s_waitcnt lgkmcnt(0)
  s_nop 4
  v_mfma_f32_16x16x16_bf16 v[100:103], v[96:97], v[76:77], v[100:103]
  s_nop 7
  v_mul_f32 v104, 0x4038aa3b, v100
  v_mul_f32 v105, 0x4038aa3b, v101
  v_mul_f32 v106, 0x4038aa3b, v102
  v_mul_f32 v107, 0x4038aa3b, v103
  buffer_store_dwordx4 v[104:107], v51, s[32:35], s63 offen sc1
  ds_read_b64_tr_b16 v[80:81], v55 offset:0
  ds_read_b64_tr_b16 v[82:83], v55 offset:4608
  ds_read_b64_tr_b16 v[84:85], v55 offset:9216
  ds_read_b64_tr_b16 v[86:87], v55 offset:13824
  ds_read_b64_tr_b16 v[88:89], v55 offset:18432
  ds_read_b64_tr_b16 v[90:91], v55 offset:23040
  ds_read_b64_tr_b16 v[92:93], v55 offset:27648
  ds_read_b64_tr_b16 v[94:95], v55 offset:32256
  ds_read_b64_tr_b16 v[96:97], v55 offset:36864
  s_waitcnt lgkmcnt(7)
  v_mfma_f32_16x16x32_bf16 v[108:111], v[80:83], v[56:59], 0
  s_waitcnt lgkmcnt(5)
  v_mfma_f32_16x16x32_bf16 v[108:111], v[84:87], v[56:59], v[108:111]
  s_waitcnt lgkmcnt(3)
  v_mfma_f32_16x16x32_bf16 v[108:111], v[88:91], v[56:59], v[108:111]
  s_waitcnt lgkmcnt(1)
  v_mfma_f32_16x16x32_bf16 v[108:111], v[92:95], v[56:59], v[108:111]
  s_waitcnt lgkmcnt(0)
  s_nop 4
  v_mfma_f32_16x16x16_bf16 v[108:111], v[96:97], v[56:57], v[108:111]
  s_nop 7
  buffer_store_dwordx4 v[108:111], v54, s[32:35], s67 offen offset:512 sc1
  v_add_u32 v49, 128, v49
  v_add_u32 v55, 128, v55
  s_add_u32 s67, s67, 256
  s_add_u32 s63, s63, 2048
  s_add_u32 s66, s66, 4
  s_cmp_lt_u32 s66, 9
  s_cbranch_scc1 L_sp1
  s_waitcnt vmcnt(0)
  s_barrier
  s_cmp_eq_u32 s59, 0
  s_cbranch_scc0 L_sp2
  s_add_u32 s61, s54, 764
  s_lshl_b32 s61, s61, 7
  v_lshlrev_b32 v53, 2, v1
  s_mov_b32 exec_hi, 0
  buffer_store_dword v52, v53, s[32:35], s61 offen sc1
L_sp2:
  s_endpgm
L_codeend:
.section .rodata,"a"
.p2align 6
.amdhsa_kernel standalone__seq2seq_rnn_t_joint__speech_kernel
  .amdhsa_next_free_vgpr 512
  .amdhsa_next_free_sgpr 102
  .amdhsa_accum_offset 256
  .amdhsa_group_segment_fixed_size 0
  .amdhsa_kernarg_size 80
  .amdhsa_user_sgpr_count 2
  .amdhsa_user_sgpr_kernarg_segment_ptr 1
  .amdhsa_system_sgpr_workgroup_id_x 1
.end_amdhsa_kernel
```
